```python
import torch

def _softmax(x, axis=-1):
    return torch.softmax(x, dim=axis)
def _gelu(x):
    return torch.nn.functional.gelu(x, approximate="tanh")
def _silu(x):
    return torch.nn.functional.silu(x)
def _sigmoid(x):
    return torch.sigmoid(x)
def _layernorm(x, axis=-1, eps=1e-5):
    m = x.mean(dim=axis, keepdim=True)
    v = x.var(dim=axis, keepdim=True, unbiased=False)
    return (x - m) / torch.sqrt(v + eps)
def _scatter_add(tgt, idx, src, axis=0):
    return tgt.clone().index_add_(axis, idx, src)
def _segment_sum(src, seg, n):
    out = torch.zeros((n,) + src.shape[1:], dtype=src.dtype)
    return out.index_add_(0, seg, src)
def _pad(x, pw):
    flat = tuple(v for pair in reversed(pw) for v in pair)
    return torch.nn.functional.pad(x, flat)

kernel_name = 'recurrent_scan__mha_block_cached__mixer_token_mlp__decode'

def setup_inputs():

    _w = (lambda a: (lambda t: t.to(torch.bfloat16) if t.is_floating_point() else t)(torch.as_tensor(a)))
    def _A_setup():
        B, Sq, D = 8, 1, 512
        H, Sk, Dh = 32, 8192, 128
        return {
            "x": _w((lambda *s: torch.randn(*s, dtype=torch.bfloat16) * 0.4)(B, Sq, D)),
            "k_cache": _w((lambda *s: torch.randn(*s, dtype=torch.bfloat16) * 1.6)(B, H, Sk, Dh)),
            "v_cache": _w((lambda *s: torch.randn(*s, dtype=torch.bfloat16) * 1.6)(B, H, Sk, Dh)),
            "wq": _w((lambda *s: torch.randn(*s, dtype=torch.bfloat16) * 1.6)(D, H * Dh) * (D ** -0.5)),
            "wo": _w((lambda *s: torch.randn(*s, dtype=torch.bfloat16) * 1.6)(H * Dh, D) * ((H * Dh) ** -0.5)),
        }
    _A_in = _A_setup()

    def _B_setup():
        B, S, D, F = 8, 1, 512, 1792
        return {
            "x": _w((lambda *s: torch.randn(*s, dtype=torch.bfloat16) * 0.4)(B, S, D)),
            "w1": _w((lambda *s: torch.randn(*s, dtype=torch.bfloat16) * 1.6)(S, F) * (S ** -0.5)),
            "b1": _w((lambda *s: torch.randn(*s, dtype=torch.bfloat16) * 1.6)(F) * 0.02),
            "w2": _w((lambda *s: torch.randn(*s, dtype=torch.bfloat16) * 1.6)(F, S) * (F ** -0.5)),
            "b2": _w((lambda *s: torch.randn(*s, dtype=torch.bfloat16) * 1.6)(S) * 0.02),
        }
    _B_in = _B_setup()

    return {
        "A_x": _A_in["x"],
        "A_k_cache": _A_in["k_cache"],
        "A_v_cache": _A_in["v_cache"],
        "A_wq": _A_in["wq"],
        "A_wo": _A_in["wo"],
        "B_x": _B_in["x"],
        "B_w1": _B_in["w1"],
        "B_b1": _B_in["b1"],
        "B_w2": _B_in["w2"],
        "B_b2": _B_in["b2"],
    }

def reference(A_x, A_k_cache, A_v_cache, A_wq, A_wo, B_x, B_w1, B_b1, B_w2, B_b2):
    def _A_ref(x, k_cache, v_cache, wq, wo):
        B, Sq, D = x.shape
        H, Dh = 32, 128
        q = (lambda x, *d: x.permute(*d))((x @ wq).reshape(B, Sq, H, Dh), 0, 2, 1, 3)
        scores = torch.einsum("bhqd,bhkd->bhqk", q, k_cache) * (Dh ** -0.5)
        p = _softmax(scores, axis=-1)
        o = torch.einsum("bhqk,bhkd->bhqd", p, v_cache)
        return (lambda x, *d: x.permute(*d))(o, 0, 2, 1, 3).reshape(B, Sq, H * Dh) @ wo

    def _B_ref(x, w1, b1, w2, b2):
        B, S, D = x.shape
        h = _layernorm(x, axis=-1)
        u = torch.einsum("bsd,sf->bdf", h, w1) + b1
        u = _gelu(u)
        y = torch.einsum("bdf,fs->bds", u, w2) + b2
        return (lambda x, *d: x.permute(*d))(y, 0, 2, 1)

    x = A_x
    xn = _layernorm(x, axis=-1)
    s = _A_ref(xn, A_k_cache, A_v_cache, A_wq, A_wo)
    g = _silu(_B_ref(xn, B_w1, B_b1, B_w2, B_b2))
    return x + s * g
```

```asm
; @launch grid=(256,1,1) block=(512,1,1) lds=64768
.amdgcn_target "amdgcn-amd-amdhsa--gfx950"
.text
.globl recurrent_scan__mha_block_cached__mixer_token_mlp__decode_kernel
.p2align 8
.type recurrent_scan__mha_block_cached__mixer_token_mlp__decode_kernel,@function
recurrent_scan__mha_block_cached__mixer_token_mlp__decode_kernel:
  s_cmp_ge_u32 s2, 256
  s_cbranch_scc1 L_end3
  s_memrealtime s[94:95]
  s_load_dwordx16 s[4:19], s[0:1], 0
  s_lshr_b32 s30, s2, 4
  s_lshl_b32 s30, s30, 3
  s_and_b32 s31, s2, 7
  s_or_b32 s30, s30, s31
  s_and_b32 s31, s2, 8
  s_lshl_b32 s31, s31, 4
  s_or_b32 s2, s30, s31
  s_load_dwordx8 s[20:27], s[0:1], 64
  s_load_dwordx2 s[28:29], s[0:1], 96
  v_lshrrev_b32 v63, 6, v0
  v_and_b32 v1, 63, v0
  v_readfirstlane_b32 s74, v63
  s_lshr_b32 s72, s2, 5
  s_and_b32 s73, s2, 31
  v_lshlrev_b32 v3, 4, v1
  v_lshrrev_b32 v8, 4, v1
  v_and_b32 v9, 15, v1
  s_and_b32 s91, s74, 3
  s_and_b32 s100, s72, 1
  s_and_b32 s79, s72, 3
  s_lshl_b32 s79, s79, 10
  s_lshr_b32 s101, s2, 7
  s_lshr_b32 s77, s73, 4
  s_and_b32 s78, s73, 15
  s_lshl_b32 s77, s77, 12
  s_lshl_b32 s78, s78, 6
  s_add_u32 s92, s77, s78
  s_add_u32 s92, s92, s79
  s_cmp_ge_u32 s74, 4
  s_cbranch_scc1 L_stream
  s_setprio 3
  s_lshr_b32 s98, s72, 0
  s_mul_i32 s98, s98, 4
  s_and_b32 s98, s98, 31
  v_add_u32 v10, s98, v9
  v_and_b32 v10, 31, v10
  v_lshl_add_u32 v10, v10, 2, v8
  s_lshl_b32 s77, s91, 7
  v_add_u32 v10, s77, v10
  v_lshlrev_b32 v10, 1, v10
  v_xor_b32 v63, 128, v10
  s_lshl_b32 s98, s98, 15
  v_lshlrev_b32 v12, 13, v8
  v_lshl_add_u32 v12, v9, 4, v12
  s_lshl_b32 s77, s91, 20
  s_lshl_b32 s99, s73, 8
  s_add_u32 s77, s77, s99
  v_add_u32 v12, s77, v12
  v_lshlrev_b32 v11, 1, v9
  s_add_u32 s78, s79, 4096
  s_waitcnt lgkmcnt(0)
  s_mov_b32 s48, s4
  s_and_b32 s49, s5, 0xffff
  s_mov_b32 s50, 8192
  s_mov_b32 s51, 0x00020000
  buffer_load_dwordx4 v[48:51], v3, s[48:51], s79 offen
  buffer_load_dwordx4 v[52:55], v3, s[48:51], s78 offen
  buffer_load_ushort v56, v10, s[48:51], s79 offen
  buffer_load_ushort v57, v63, s[48:51], s79 offen
  buffer_load_ushort v58, v10, s[48:51], s78 offen
  buffer_load_ushort v59, v63, s[48:51], s78 offen
  s_mov_b32 s40, s10
  s_and_b32 s41, s11, 0xffff
  s_mov_b32 s42, 4194304
  s_mov_b32 s43, 0x00020000
  buffer_load_dwordx4 v[64:67], v12, s[40:43], s98 offen
  s_add_u32 s98, s98, 32768
  s_and_b32 s98, s98, 0xfffff
  buffer_load_dwordx4 v[68:71], v12, s[40:43], s98 offen
  s_add_u32 s98, s98, 32768
  s_and_b32 s98, s98, 0xfffff
  buffer_load_dwordx4 v[72:75], v12, s[40:43], s98 offen
  s_add_u32 s98, s98, 32768
  s_and_b32 s98, s98, 0xfffff
  buffer_load_dwordx4 v[76:79], v12, s[40:43], s98 offen
  s_add_u32 s98, s98, 32768
  s_and_b32 s98, s98, 0xfffff
  buffer_load_dwordx4 v[80:83], v12, s[40:43], s98 offen
  s_add_u32 s98, s98, 32768
  s_and_b32 s98, s98, 0xfffff
  buffer_load_dwordx4 v[84:87], v12, s[40:43], s98 offen
  s_add_u32 s98, s98, 32768
  s_and_b32 s98, s98, 0xfffff
  buffer_load_dwordx4 v[88:91], v12, s[40:43], s98 offen
  s_add_u32 s98, s98, 32768
  s_and_b32 s98, s98, 0xfffff
  buffer_load_dwordx4 v[92:95], v12, s[40:43], s98 offen
  s_add_u32 s98, s98, 32768
  s_and_b32 s98, s98, 0xfffff
  s_mov_b32 s68, s28
  s_and_b32 s69, s29, 0xffff
  s_mov_b32 s70, 1646592
  s_mov_b32 s71, 0x00020000
  s_mov_b32 s80, 0x3db504f3
  s_mov_b32 s81, 0x3fb8aa3b
  s_mov_b32 s83, 0xbfb8aa3b
  s_mov_b32 s82, 0xffff0000
  v_and_b32 v63, 1, v1
  v_cmp_eq_u32 vcc, 1, v63
  v_mov_b32 v14, 0xffff
  v_mov_b32 v15, s82
  v_cndmask_b32 v14, v14, v15, vcc
  v_lshrrev_b32 v63, 1, v9
  v_cmp_eq_u32 vcc, 0, v63
  s_nop 1
  v_cndmask_b32 v4, 0, v14, vcc
  v_cmp_eq_u32 vcc, 1, v63
  s_nop 1
  v_cndmask_b32 v5, 0, v14, vcc
  v_cmp_eq_u32 vcc, 2, v63
  s_nop 1
  v_cndmask_b32 v6, 0, v14, vcc
  v_cmp_eq_u32 vcc, 3, v63
  s_nop 1
  v_cndmask_b32 v7, 0, v14, vcc
  v_mov_b32 v14, 0x0c0c0100
  v_mov_b32 v15, 0x0c0c0302
  v_cmp_gt_u32 vcc, 8, v9
  s_nop 1
  v_cndmask_b32 v14, v15, v14, vcc
  v_alignbit_b32 v15, v14, v14, 16
  v_and_b32 v63, 1, v1
  v_cmp_eq_u32 vcc, 1, v63
  s_nop 1
  v_cndmask_b32 v14, v14, v15, vcc
  v_mov_b32 v15, 0x0c0c0c0c
  v_bfe_u32 v63, v9, 1, 2
  v_cmp_eq_u32 vcc, 0, v63
  s_nop 1
  v_cndmask_b32 v224, v15, v14, vcc
  v_cmp_eq_u32 vcc, 1, v63
  s_nop 1
  v_cndmask_b32 v225, v15, v14, vcc
  v_cmp_eq_u32 vcc, 2, v63
  s_nop 1
  v_cndmask_b32 v226, v15, v14, vcc
  v_cmp_eq_u32 vcc, 3, v63
  s_nop 1
  v_cndmask_b32 v227, v15, v14, vcc
  v_lshrrev_b32 v62, 3, v9
  v_lshlrev_b32 v62, 11, v62
  v_lshl_add_u32 v62, v8, 7, v62
  v_and_b32 v63, 7, v9
  v_lshl_add_u32 v62, v63, 2, v62
  s_lshl_b32 s77, s91, 9
  s_add_u32 s77, s77, 32768
  v_add_u32 v62, s77, v62
  s_waitcnt vmcnt(12)
  v_lshlrev_b32 v16, 16, v48
  v_and_b32 v17, s82, v48
  v_lshlrev_b32 v18, 16, v49
  v_and_b32 v19, s82, v49
  v_lshlrev_b32 v20, 16, v50
  v_and_b32 v21, s82, v50
  v_lshlrev_b32 v22, 16, v51
  v_and_b32 v23, s82, v51
  v_lshlrev_b32 v24, 16, v52
  v_and_b32 v25, s82, v52
  v_lshlrev_b32 v26, 16, v53
  v_and_b32 v27, s82, v53
  v_lshlrev_b32 v28, 16, v54
  v_and_b32 v29, s82, v54
  v_lshlrev_b32 v30, 16, v55
  v_and_b32 v31, s82, v55
  v_add_f32 v36, v16, v17
  v_add_f32 v42, v24, v25
  v_add_f32 v36, v36, v18
  v_add_f32 v42, v42, v26
  v_add_f32 v36, v36, v19
  v_add_f32 v42, v42, v27
  v_add_f32 v36, v36, v20
  v_add_f32 v42, v42, v28
  v_add_f32 v36, v36, v21
  v_add_f32 v42, v42, v29
  v_add_f32 v36, v36, v22
  v_add_f32 v42, v42, v30
  v_add_f32 v36, v36, v23
  v_add_f32 v42, v42, v31
  s_nop 0
  v_add_f32_dpp v36, v36, v36 quad_perm:[1,0,3,2] row_mask:0xf bank_mask:0xf
  v_add_f32_dpp v42, v42, v42 quad_perm:[1,0,3,2] row_mask:0xf bank_mask:0xf
  s_nop 0
  v_add_f32_dpp v36, v36, v36 quad_perm:[2,3,0,1] row_mask:0xf bank_mask:0xf
  v_add_f32_dpp v42, v42, v42 quad_perm:[2,3,0,1] row_mask:0xf bank_mask:0xf
  s_nop 0
  v_add_f32_dpp v36, v36, v36 row_ror:4 row_mask:0xf bank_mask:0xf
  v_add_f32_dpp v42, v42, v42 row_ror:4 row_mask:0xf bank_mask:0xf
  s_nop 0
  v_add_f32_dpp v36, v36, v36 row_ror:8 row_mask:0xf bank_mask:0xf
  v_add_f32_dpp v42, v42, v42 row_ror:8 row_mask:0xf bank_mask:0xf
  v_readlane_b32 s84, v36, 0
  v_readlane_b32 s85, v36, 16
  v_readlane_b32 s86, v36, 32
  v_readlane_b32 s87, v36, 48
  v_readlane_b32 s32, v42, 0
  v_readlane_b32 s33, v42, 16
  v_readlane_b32 s34, v42, 32
  v_readlane_b32 s35, v42, 48
  v_mov_b32 v36, s84
  v_mov_b32 v42, s32
  v_add_f32 v36, s85, v36
  v_add_f32 v42, s33, v42
  v_add_f32 v36, s86, v36
  v_add_f32 v42, s34, v42
  v_add_f32 v36, s87, v36
  v_add_f32 v42, s35, v42
  v_mul_f32 v36, 0x3b000000, v36
  v_mul_f32 v42, 0x3b000000, v42
  v_sub_f32 v37, v16, v36
  v_sub_f32 v43, v24, v42
  v_mul_f32 v38, v37, v37
  v_mul_f32 v44, v43, v43
  v_sub_f32 v37, v17, v36
  v_sub_f32 v43, v25, v42
  v_fmac_f32 v38, v37, v37
  v_fmac_f32 v44, v43, v43
  v_sub_f32 v37, v18, v36
  v_sub_f32 v43, v26, v42
  v_fmac_f32 v38, v37, v37
  v_fmac_f32 v44, v43, v43
  v_sub_f32 v37, v19, v36
  v_sub_f32 v43, v27, v42
  v_fmac_f32 v38, v37, v37
  v_fmac_f32 v44, v43, v43
  v_sub_f32 v37, v20, v36
  v_sub_f32 v43, v28, v42
  v_fmac_f32 v38, v37, v37
  v_fmac_f32 v44, v43, v43
  v_sub_f32 v37, v21, v36
  v_sub_f32 v43, v29, v42
  v_fmac_f32 v38, v37, v37
  v_fmac_f32 v44, v43, v43
  v_sub_f32 v37, v22, v36
  v_sub_f32 v43, v30, v42
  v_fmac_f32 v38, v37, v37
  v_fmac_f32 v44, v43, v43
  v_sub_f32 v37, v23, v36
  v_sub_f32 v43, v31, v42
  v_fmac_f32 v38, v37, v37
  v_fmac_f32 v44, v43, v43
  s_nop 0
  v_add_f32_dpp v38, v38, v38 quad_perm:[1,0,3,2] row_mask:0xf bank_mask:0xf
  v_add_f32_dpp v44, v44, v44 quad_perm:[1,0,3,2] row_mask:0xf bank_mask:0xf
  s_nop 0
  v_add_f32_dpp v38, v38, v38 quad_perm:[2,3,0,1] row_mask:0xf bank_mask:0xf
  v_add_f32_dpp v44, v44, v44 quad_perm:[2,3,0,1] row_mask:0xf bank_mask:0xf
  s_nop 0
  v_add_f32_dpp v38, v38, v38 row_ror:4 row_mask:0xf bank_mask:0xf
  v_add_f32_dpp v44, v44, v44 row_ror:4 row_mask:0xf bank_mask:0xf
  s_nop 0
  v_add_f32_dpp v38, v38, v38 row_ror:8 row_mask:0xf bank_mask:0xf
  v_add_f32_dpp v44, v44, v44 row_ror:8 row_mask:0xf bank_mask:0xf
  v_readlane_b32 s84, v38, 0
  v_readlane_b32 s85, v38, 16
  v_readlane_b32 s86, v38, 32
  v_readlane_b32 s87, v38, 48
  v_readlane_b32 s32, v44, 0
  v_readlane_b32 s33, v44, 16
  v_readlane_b32 s34, v44, 32
  v_readlane_b32 s35, v44, 48
  v_mov_b32 v38, s84
  v_mov_b32 v44, s32
  v_add_f32 v38, s85, v38
  v_add_f32 v44, s33, v44
  v_add_f32 v38, s86, v38
  v_add_f32 v44, s34, v44
  v_add_f32 v38, s87, v38
  v_add_f32 v44, s35, v44
  v_mul_f32 v38, 0x3b000000, v38
  v_mul_f32 v44, 0x3b000000, v44
  v_cvt_pk_bf16_f32 v39, v36, v36
  v_and_b32 v39, s82, v39
  v_cvt_pk_bf16_f32 v45, v42, v42
  v_and_b32 v45, s82, v45
  v_cvt_pk_bf16_f32 v38, v38, v38
  v_and_b32 v38, s82, v38
  v_cvt_pk_bf16_f32 v44, v44, v44
  v_and_b32 v44, s82, v44
  v_add_f32 v38, 0x3727c5ac, v38
  v_add_f32 v44, 0x3727c5ac, v44
  v_cvt_pk_bf16_f32 v38, v38, v38
  v_and_b32 v38, s82, v38
  v_cvt_pk_bf16_f32 v44, v44, v44
  v_and_b32 v44, s82, v44
  v_sqrt_f32 v38, v38
  v_sqrt_f32 v44, v44
  v_cvt_pk_bf16_f32 v40, v38, v38
  v_and_b32 v40, s82, v40
  v_cvt_pk_bf16_f32 v46, v44, v44
  v_and_b32 v46, s82, v46
  v_rcp_f32 v41, v40
  v_rcp_f32 v47, v46
  s_waitcnt vmcnt(8)
  v_lshlrev_b32 v56, 16, v56
  v_lshlrev_b32 v57, 16, v57
  v_lshlrev_b32 v58, 16, v58
  v_lshlrev_b32 v59, 16, v59
  v_sub_f32 v56, v56, v39
  v_cvt_pk_bf16_f32 v56, v56, v56
  v_and_b32 v56, s82, v56
  v_mul_f32 v37, v56, v41
  v_fma_f32 v38, -v37, v40, v56
  v_fma_f32 v56, v38, v41, v37
  v_sub_f32 v57, v57, v39
  v_cvt_pk_bf16_f32 v57, v57, v57
  v_and_b32 v57, s82, v57
  v_mul_f32 v37, v57, v41
  v_fma_f32 v38, -v37, v40, v57
  v_fma_f32 v57, v38, v41, v37
  v_sub_f32 v58, v58, v45
  v_cvt_pk_bf16_f32 v58, v58, v58
  v_and_b32 v58, s82, v58
  v_mul_f32 v43, v58, v47
  v_fma_f32 v44, -v43, v46, v58
  v_fma_f32 v58, v44, v47, v43
  v_sub_f32 v59, v59, v45
  v_cvt_pk_bf16_f32 v59, v59, v59
  v_and_b32 v59, s82, v59
  v_mul_f32 v43, v59, v47
  v_fma_f32 v44, -v43, v46, v59
  v_fma_f32 v59, v44, v47, v43
  v_cvt_pk_bf16_f32 v56, v56, v58
  v_cvt_pk_bf16_f32 v57, v57, v59
  s_nop 0
  v_mov_b32_dpp v228, v56 row_newbcast:0 row_mask:0xf bank_mask:0xf
  v_perm_b32 v208, v228, v228, v224
  v_perm_b32 v209, v228, v228, v225
  v_perm_b32 v210, v228, v228, v226
  v_perm_b32 v211, v228, v228, v227
  s_waitcnt vmcnt(3)
  buffer_load_dwordx4 v[96:99], v12, s[40:43], s98 offen
  s_add_u32 s98, s98, 32768
  s_and_b32 s98, s98, 0xfffff
  v_mfma_f32_16x16x32_bf16 v[32:35], v[64:67], v[208:211], 0
  v_mov_b32_dpp v229, v56 row_newbcast:1 row_mask:0xf bank_mask:0xf
  v_perm_b32 v212, v229, v229, v224
  v_perm_b32 v213, v229, v229, v225
  v_perm_b32 v214, v229, v229, v226
  v_perm_b32 v215, v229, v229, v227
  s_waitcnt vmcnt(3)
  buffer_load_dwordx4 v[100:103], v12, s[40:43], s98 offen
  s_add_u32 s98, s98, 32768
  s_and_b32 s98, s98, 0xfffff
  v_mfma_f32_16x16x32_bf16 v[32:35], v[68:71], v[212:215], v[32:35]
  v_mov_b32_dpp v230, v56 row_newbcast:2 row_mask:0xf bank_mask:0xf
  v_perm_b32 v216, v230, v230, v224
  v_perm_b32 v217, v230, v230, v225
  v_perm_b32 v218, v230, v230, v226
  v_perm_b32 v219, v230, v230, v227
  s_waitcnt vmcnt(3)
  buffer_load_dwordx4 v[104:107], v12, s[40:43], s98 offen
  s_add_u32 s98, s98, 32768
  s_and_b32 s98, s98, 0xfffff
  v_mfma_f32_16x16x32_bf16 v[32:35], v[72:75], v[216:219], v[32:35]
  v_mov_b32_dpp v231, v56 row_newbcast:3 row_mask:0xf bank_mask:0xf
  v_perm_b32 v220, v231, v231, v224
  v_perm_b32 v221, v231, v231, v225
  v_perm_b32 v222, v231, v231, v226
  v_perm_b32 v223, v231, v231, v227
  s_waitcnt vmcnt(3)
  buffer_load_dwordx4 v[108:111], v12, s[40:43], s98 offen
  s_add_u32 s98, s98, 32768
  s_and_b32 s98, s98, 0xfffff
  v_mfma_f32_16x16x32_bf16 v[32:35], v[76:79], v[220:223], v[32:35]
  v_mov_b32_dpp v228, v56 row_newbcast:4 row_mask:0xf bank_mask:0xf
  v_perm_b32 v208, v228, v228, v224
  v_perm_b32 v209, v228, v228, v225
  v_perm_b32 v210, v228, v228, v226
  v_perm_b32 v211, v228, v228, v227
  s_waitcnt vmcnt(3)
  buffer_load_dwordx4 v[112:115], v12, s[40:43], s98 offen
  s_add_u32 s98, s98, 32768
  s_and_b32 s98, s98, 0xfffff
  v_mfma_f32_16x16x32_bf16 v[32:35], v[80:83], v[208:211], v[32:35]
  v_mov_b32_dpp v229, v56 row_newbcast:5 row_mask:0xf bank_mask:0xf
  v_perm_b32 v212, v229, v229, v224
  v_perm_b32 v213, v229, v229, v225
  v_perm_b32 v214, v229, v229, v226
  v_perm_b32 v215, v229, v229, v227
  s_waitcnt vmcnt(3)
  buffer_load_dwordx4 v[116:119], v12, s[40:43], s98 offen
  s_add_u32 s98, s98, 32768
  s_and_b32 s98, s98, 0xfffff
  v_mfma_f32_16x16x32_bf16 v[32:35], v[84:87], v[212:215], v[32:35]
  v_mov_b32_dpp v230, v56 row_newbcast:6 row_mask:0xf bank_mask:0xf
  v_perm_b32 v216, v230, v230, v224
  v_perm_b32 v217, v230, v230, v225
  v_perm_b32 v218, v230, v230, v226
  v_perm_b32 v219, v230, v230, v227
  s_waitcnt vmcnt(3)
  buffer_load_dwordx4 v[120:123], v12, s[40:43], s98 offen
  s_add_u32 s98, s98, 32768
  s_and_b32 s98, s98, 0xfffff
  v_mfma_f32_16x16x32_bf16 v[32:35], v[88:91], v[216:219], v[32:35]
  v_mov_b32_dpp v231, v56 row_newbcast:7 row_mask:0xf bank_mask:0xf
  v_perm_b32 v220, v231, v231, v224
  v_perm_b32 v221, v231, v231, v225
  v_perm_b32 v222, v231, v231, v226
  v_perm_b32 v223, v231, v231, v227
  s_waitcnt vmcnt(3)
  buffer_load_dwordx4 v[124:127], v12, s[40:43], s98 offen
  s_add_u32 s98, s98, 32768
  s_and_b32 s98, s98, 0xfffff
  v_mfma_f32_16x16x32_bf16 v[32:35], v[92:95], v[220:223], v[32:35]
  v_mov_b32_dpp v228, v56 row_newbcast:8 row_mask:0xf bank_mask:0xf
  v_perm_b32 v208, v228, v228, v224
  v_perm_b32 v209, v228, v228, v225
  v_perm_b32 v210, v228, v228, v226
  v_perm_b32 v211, v228, v228, v227
  s_waitcnt vmcnt(3)
  buffer_load_dwordx4 v[128:131], v12, s[40:43], s98 offen
  s_add_u32 s98, s98, 32768
  s_and_b32 s98, s98, 0xfffff
  v_mfma_f32_16x16x32_bf16 v[32:35], v[96:99], v[208:211], v[32:35]
  v_mov_b32_dpp v229, v56 row_newbcast:9 row_mask:0xf bank_mask:0xf
  v_perm_b32 v212, v229, v229, v224
  v_perm_b32 v213, v229, v229, v225
  v_perm_b32 v214, v229, v229, v226
  v_perm_b32 v215, v229, v229, v227
  s_waitcnt vmcnt(3)
  buffer_load_dwordx4 v[132:135], v12, s[40:43], s98 offen
  s_add_u32 s98, s98, 32768
  s_and_b32 s98, s98, 0xfffff
  v_mfma_f32_16x16x32_bf16 v[32:35], v[100:103], v[212:215], v[32:35]
  v_mov_b32_dpp v230, v56 row_newbcast:10 row_mask:0xf bank_mask:0xf
  v_perm_b32 v216, v230, v230, v224
  v_perm_b32 v217, v230, v230, v225
  v_perm_b32 v218, v230, v230, v226
  v_perm_b32 v219, v230, v230, v227
  s_waitcnt vmcnt(3)
  buffer_load_dwordx4 v[136:139], v12, s[40:43], s98 offen
  s_add_u32 s98, s98, 32768
  s_and_b32 s98, s98, 0xfffff
  v_mfma_f32_16x16x32_bf16 v[32:35], v[104:107], v[216:219], v[32:35]
  v_mov_b32_dpp v231, v56 row_newbcast:11 row_mask:0xf bank_mask:0xf
  v_perm_b32 v220, v231, v231, v224
  v_perm_b32 v221, v231, v231, v225
  v_perm_b32 v222, v231, v231, v226
  v_perm_b32 v223, v231, v231, v227
  s_waitcnt vmcnt(3)
  buffer_load_dwordx4 v[140:143], v12, s[40:43], s98 offen
  s_add_u32 s98, s98, 32768
  s_and_b32 s98, s98, 0xfffff
  v_mfma_f32_16x16x32_bf16 v[32:35], v[108:111], v[220:223], v[32:35]
  v_mov_b32_dpp v228, v56 row_newbcast:12 row_mask:0xf bank_mask:0xf
  v_perm_b32 v208, v228, v228, v224
  v_perm_b32 v209, v228, v228, v225
  v_perm_b32 v210, v228, v228, v226
  v_perm_b32 v211, v228, v228, v227
  s_waitcnt vmcnt(3)
  buffer_load_dwordx4 v[144:147], v12, s[40:43], s98 offen
  s_add_u32 s98, s98, 32768
  s_and_b32 s98, s98, 0xfffff
  v_mfma_f32_16x16x32_bf16 v[32:35], v[112:115], v[208:211], v[32:35]
  v_mov_b32_dpp v229, v56 row_newbcast:13 row_mask:0xf bank_mask:0xf
  v_perm_b32 v212, v229, v229, v224
  v_perm_b32 v213, v229, v229, v225
  v_perm_b32 v214, v229, v229, v226
  v_perm_b32 v215, v229, v229, v227
  s_waitcnt vmcnt(3)
  buffer_load_dwordx4 v[148:151], v12, s[40:43], s98 offen
  s_add_u32 s98, s98, 32768
  s_and_b32 s98, s98, 0xfffff
  v_mfma_f32_16x16x32_bf16 v[32:35], v[116:119], v[212:215], v[32:35]
  v_mov_b32_dpp v230, v56 row_newbcast:14 row_mask:0xf bank_mask:0xf
  v_perm_b32 v216, v230, v230, v224
  v_perm_b32 v217, v230, v230, v225
  v_perm_b32 v218, v230, v230, v226
  v_perm_b32 v219, v230, v230, v227
  s_waitcnt vmcnt(3)
  buffer_load_dwordx4 v[152:155], v12, s[40:43], s98 offen
  s_add_u32 s98, s98, 32768
  s_and_b32 s98, s98, 0xfffff
  v_mfma_f32_16x16x32_bf16 v[32:35], v[120:123], v[216:219], v[32:35]
  v_mov_b32_dpp v231, v56 row_newbcast:15 row_mask:0xf bank_mask:0xf
  v_perm_b32 v220, v231, v231, v224
  v_perm_b32 v221, v231, v231, v225
  v_perm_b32 v222, v231, v231, v226
  v_perm_b32 v223, v231, v231, v227
  s_waitcnt vmcnt(3)
  buffer_load_dwordx4 v[156:159], v12, s[40:43], s98 offen
  s_add_u32 s98, s98, 32768
  s_and_b32 s98, s98, 0xfffff
  v_mfma_f32_16x16x32_bf16 v[32:35], v[124:127], v[220:223], v[32:35]
  v_mov_b32_dpp v228, v57 row_newbcast:0 row_mask:0xf bank_mask:0xf
  v_perm_b32 v208, v228, v228, v224
  v_perm_b32 v209, v228, v228, v225
  v_perm_b32 v210, v228, v228, v226
  v_perm_b32 v211, v228, v228, v227
  s_waitcnt vmcnt(3)
  buffer_load_dwordx4 v[160:163], v12, s[40:43], s98 offen
  s_add_u32 s98, s98, 32768
  s_and_b32 s98, s98, 0xfffff
  v_mfma_f32_16x16x32_bf16 v[32:35], v[128:131], v[208:211], v[32:35]
  v_mov_b32_dpp v229, v57 row_newbcast:1 row_mask:0xf bank_mask:0xf
  v_perm_b32 v212, v229, v229, v224
  v_perm_b32 v213, v229, v229, v225
  v_perm_b32 v214, v229, v229, v226
  v_perm_b32 v215, v229, v229, v227
  s_waitcnt vmcnt(3)
  buffer_load_dwordx4 v[164:167], v12, s[40:43], s98 offen
  s_add_u32 s98, s98, 32768
  s_and_b32 s98, s98, 0xfffff
  v_mfma_f32_16x16x32_bf16 v[32:35], v[132:135], v[212:215], v[32:35]
  v_mov_b32_dpp v230, v57 row_newbcast:2 row_mask:0xf bank_mask:0xf
  v_perm_b32 v216, v230, v230, v224
  v_perm_b32 v217, v230, v230, v225
  v_perm_b32 v218, v230, v230, v226
  v_perm_b32 v219, v230, v230, v227
  s_waitcnt vmcnt(3)
  buffer_load_dwordx4 v[168:171], v12, s[40:43], s98 offen
  s_add_u32 s98, s98, 32768
  s_and_b32 s98, s98, 0xfffff
  v_mfma_f32_16x16x32_bf16 v[32:35], v[136:139], v[216:219], v[32:35]
  v_mov_b32_dpp v231, v57 row_newbcast:3 row_mask:0xf bank_mask:0xf
  v_perm_b32 v220, v231, v231, v224
  v_perm_b32 v221, v231, v231, v225
  v_perm_b32 v222, v231, v231, v226
  v_perm_b32 v223, v231, v231, v227
  s_waitcnt vmcnt(3)
  buffer_load_dwordx4 v[172:175], v12, s[40:43], s98 offen
  s_add_u32 s98, s98, 32768
  s_and_b32 s98, s98, 0xfffff
  v_mfma_f32_16x16x32_bf16 v[32:35], v[140:143], v[220:223], v[32:35]
  v_mov_b32_dpp v228, v57 row_newbcast:4 row_mask:0xf bank_mask:0xf
  v_perm_b32 v208, v228, v228, v224
  v_perm_b32 v209, v228, v228, v225
  v_perm_b32 v210, v228, v228, v226
  v_perm_b32 v211, v228, v228, v227
  s_waitcnt vmcnt(3)
  buffer_load_dwordx4 v[176:179], v12, s[40:43], s98 offen
  s_add_u32 s98, s98, 32768
  s_and_b32 s98, s98, 0xfffff
  v_mfma_f32_16x16x32_bf16 v[32:35], v[144:147], v[208:211], v[32:35]
  v_mov_b32_dpp v229, v57 row_newbcast:5 row_mask:0xf bank_mask:0xf
  v_perm_b32 v212, v229, v229, v224
  v_perm_b32 v213, v229, v229, v225
  v_perm_b32 v214, v229, v229, v226
  v_perm_b32 v215, v229, v229, v227
  s_waitcnt vmcnt(3)
  buffer_load_dwordx4 v[180:183], v12, s[40:43], s98 offen
  s_add_u32 s98, s98, 32768
  s_and_b32 s98, s98, 0xfffff
  v_mfma_f32_16x16x32_bf16 v[32:35], v[148:151], v[212:215], v[32:35]
  v_mov_b32_dpp v230, v57 row_newbcast:6 row_mask:0xf bank_mask:0xf
  v_perm_b32 v216, v230, v230, v224
  v_perm_b32 v217, v230, v230, v225
  v_perm_b32 v218, v230, v230, v226
  v_perm_b32 v219, v230, v230, v227
  s_waitcnt vmcnt(3)
  buffer_load_dwordx4 v[184:187], v12, s[40:43], s98 offen
  s_add_u32 s98, s98, 32768
  s_and_b32 s98, s98, 0xfffff
  v_mfma_f32_16x16x32_bf16 v[32:35], v[152:155], v[216:219], v[32:35]
  v_mov_b32_dpp v231, v57 row_newbcast:7 row_mask:0xf bank_mask:0xf
  v_perm_b32 v220, v231, v231, v224
  v_perm_b32 v221, v231, v231, v225
  v_perm_b32 v222, v231, v231, v226
  v_perm_b32 v223, v231, v231, v227
  s_waitcnt vmcnt(3)
  buffer_load_dwordx4 v[188:191], v12, s[40:43], s98 offen
  v_mfma_f32_16x16x32_bf16 v[32:35], v[156:159], v[220:223], v[32:35]
  v_mov_b32_dpp v228, v57 row_newbcast:8 row_mask:0xf bank_mask:0xf
  v_perm_b32 v208, v228, v228, v224
  v_perm_b32 v209, v228, v228, v225
  v_perm_b32 v210, v228, v228, v226
  v_perm_b32 v211, v228, v228, v227
  s_waitcnt vmcnt(7)
  s_nop 0
  v_mfma_f32_16x16x32_bf16 v[32:35], v[160:163], v[208:211], v[32:35]
  v_mov_b32_dpp v229, v57 row_newbcast:9 row_mask:0xf bank_mask:0xf
  v_perm_b32 v212, v229, v229, v224
  v_perm_b32 v213, v229, v229, v225
  v_perm_b32 v214, v229, v229, v226
  v_perm_b32 v215, v229, v229, v227
  s_waitcnt vmcnt(6)
  s_nop 0
  v_mfma_f32_16x16x32_bf16 v[32:35], v[164:167], v[212:215], v[32:35]
  v_mov_b32_dpp v230, v57 row_newbcast:10 row_mask:0xf bank_mask:0xf
  v_perm_b32 v216, v230, v230, v224
  v_perm_b32 v217, v230, v230, v225
  v_perm_b32 v218, v230, v230, v226
  v_perm_b32 v219, v230, v230, v227
  s_waitcnt vmcnt(5)
  s_nop 0
  v_mfma_f32_16x16x32_bf16 v[32:35], v[168:171], v[216:219], v[32:35]
  v_mov_b32_dpp v231, v57 row_newbcast:11 row_mask:0xf bank_mask:0xf
  v_perm_b32 v220, v231, v231, v224
  v_perm_b32 v221, v231, v231, v225
  v_perm_b32 v222, v231, v231, v226
  v_perm_b32 v223, v231, v231, v227
  s_waitcnt vmcnt(4)
  s_nop 0
  v_mfma_f32_16x16x32_bf16 v[32:35], v[172:175], v[220:223], v[32:35]
  v_mov_b32_dpp v228, v57 row_newbcast:12 row_mask:0xf bank_mask:0xf
  v_perm_b32 v208, v228, v228, v224
  v_perm_b32 v209, v228, v228, v225
  v_perm_b32 v210, v228, v228, v226
  v_perm_b32 v211, v228, v228, v227
  s_waitcnt vmcnt(3)
  s_nop 0
  v_mfma_f32_16x16x32_bf16 v[32:35], v[176:179], v[208:211], v[32:35]
  v_mov_b32_dpp v229, v57 row_newbcast:13 row_mask:0xf bank_mask:0xf
  v_perm_b32 v212, v229, v229, v224
  v_perm_b32 v213, v229, v229, v225
  v_perm_b32 v214, v229, v229, v226
  v_perm_b32 v215, v229, v229, v227
  s_waitcnt vmcnt(2)
  s_nop 0
  v_mfma_f32_16x16x32_bf16 v[32:35], v[180:183], v[212:215], v[32:35]
  v_mov_b32_dpp v230, v57 row_newbcast:14 row_mask:0xf bank_mask:0xf
  v_perm_b32 v216, v230, v230, v224
  v_perm_b32 v217, v230, v230, v225
  v_perm_b32 v218, v230, v230, v226
  v_perm_b32 v219, v230, v230, v227
  s_waitcnt vmcnt(1)
  s_nop 0
  v_mfma_f32_16x16x32_bf16 v[32:35], v[184:187], v[216:219], v[32:35]
  v_mov_b32_dpp v231, v57 row_newbcast:15 row_mask:0xf bank_mask:0xf
  v_perm_b32 v220, v231, v231, v224
  v_perm_b32 v221, v231, v231, v225
  v_perm_b32 v222, v231, v231, v226
  v_perm_b32 v223, v231, v231, v227
  s_waitcnt vmcnt(0)
  s_nop 0
  v_mfma_f32_16x16x32_bf16 v[32:35], v[188:191], v[220:223], v[32:35]
  s_nop 7
  ds_write2_b32 v62, v32, v33 offset0:0 offset1:8
  ds_write2_b32 v62, v34, v35 offset0:16 offset1:24
  s_waitcnt lgkmcnt(0)
  s_barrier
  s_setprio 0
  v_mov_b32 v14, 0
  s_or_b32 s77, s94, 1
  v_mov_b32 v16, s77
  v_mov_b32 v17, 0
  s_and_b32 s77, s2, 252
  s_or_b32 s77, s77, s74
  s_cmp_lg_u32 s77, 0
  s_cbranch_scc1 L_noprop
  s_mov_b64 exec, 1
  global_atomic_cmpswap v14, v[16:17], s[26:27] sc1
  s_mov_b64 exec, -1
L_noprop:
  s_cmp_lg_u32 s101, 0
  s_cbranch_scc1 L_nogelu
  s_mov_b32 s52, s16
  s_and_b32 s53, s17, 0xffff
  s_mov_b32 s54, 3584
  s_mov_b32 s55, 0x00020000
  s_mov_b32 s56, s18
  s_and_b32 s57, s19, 0xffff
  s_mov_b32 s58, 3584
  s_mov_b32 s59, 0x00020000
  s_mov_b32 s60, s20
  s_and_b32 s61, s21, 0xffff
  s_mov_b32 s62, 3584
  s_mov_b32 s63, 0x00020000
  s_and_b32 s78, s92, 0x1c00
  buffer_load_dwordx4 v[204:207], v3, s[48:51], s78 offen
  buffer_load_ushort v60, v11, s[48:51], s92 offen
  buffer_load_ushort v61, v11, s[48:51], s92 offen offset:32
  s_mul_i32 s77, s91, 896
  buffer_load_dwordx4 v[192:195], v3, s[52:55], s77 offen
  buffer_load_dwordx4 v[196:199], v3, s[56:59], s77 offen
  buffer_load_dwordx4 v[200:203], v3, s[60:63], s77 offen
  s_mov_b32 s89, 0x3ea44626
  s_waitcnt vmcnt(3)
  v_lshlrev_b32 v24, 16, v204
  v_and_b32 v25, s82, v204
  v_lshlrev_b32 v26, 16, v205
  v_and_b32 v27, s82, v205
  v_lshlrev_b32 v28, 16, v206
  v_and_b32 v29, s82, v206
  v_lshlrev_b32 v30, 16, v207
  v_and_b32 v31, s82, v207
  v_lshlrev_b32 v60, 16, v60
  v_lshlrev_b32 v61, 16, v61
  v_add_f32 v36, v24, v25
  v_add_f32 v36, v36, v26
  v_add_f32 v36, v36, v27
  v_add_f32 v36, v36, v28
  v_add_f32 v36, v36, v29
  v_add_f32 v36, v36, v30
  v_add_f32 v36, v36, v31
  s_nop 1
  v_add_f32_dpp v36, v36, v36 quad_perm:[1,0,3,2] row_mask:0xf bank_mask:0xf
  s_nop 1
  v_add_f32_dpp v36, v36, v36 quad_perm:[2,3,0,1] row_mask:0xf bank_mask:0xf
  s_nop 1
  v_add_f32_dpp v36, v36, v36 row_ror:4 row_mask:0xf bank_mask:0xf
  s_nop 1
  v_add_f32_dpp v36, v36, v36 row_ror:8 row_mask:0xf bank_mask:0xf
  s_nop 0
  v_readlane_b32 s84, v36, 0
  v_readlane_b32 s85, v36, 16
  v_readlane_b32 s86, v36, 32
  v_readlane_b32 s87, v36, 48
  v_mov_b32 v36, s84
  v_add_f32 v36, s85, v36
  v_add_f32 v36, s86, v36
  v_add_f32 v36, s87, v36
  v_mul_f32 v36, 0x3b000000, v36
  v_sub_f32 v37, v24, v36
  v_mul_f32 v38, v37, v37
  v_sub_f32 v37, v25, v36
  v_fmac_f32 v38, v37, v37
  v_sub_f32 v37, v26, v36
  v_fmac_f32 v38, v37, v37
  v_sub_f32 v37, v27, v36
  v_fmac_f32 v38, v37, v37
  v_sub_f32 v37, v28, v36
  v_fmac_f32 v38, v37, v37
  v_sub_f32 v37, v29, v36
  v_fmac_f32 v38, v37, v37
  v_sub_f32 v37, v30, v36
  v_fmac_f32 v38, v37, v37
  v_sub_f32 v37, v31, v36
  v_fmac_f32 v38, v37, v37
  s_nop 1
  v_add_f32_dpp v38, v38, v38 quad_perm:[1,0,3,2] row_mask:0xf bank_mask:0xf
  s_nop 1
  v_add_f32_dpp v38, v38, v38 quad_perm:[2,3,0,1] row_mask:0xf bank_mask:0xf
  s_nop 1
  v_add_f32_dpp v38, v38, v38 row_ror:4 row_mask:0xf bank_mask:0xf
  s_nop 1
  v_add_f32_dpp v38, v38, v38 row_ror:8 row_mask:0xf bank_mask:0xf
  s_nop 0
  v_readlane_b32 s84, v38, 0
  v_readlane_b32 s85, v38, 16
  v_readlane_b32 s86, v38, 32
  v_readlane_b32 s87, v38, 48
  v_mov_b32 v38, s84
  v_add_f32 v38, s85, v38
  v_add_f32 v38, s86, v38
  v_add_f32 v38, s87, v38
  v_mul_f32 v38, 0x3b000000, v38
  v_cvt_pk_bf16_f32 v39, v36, v36
  v_and_b32 v39, s82, v39
  v_cvt_pk_bf16_f32 v38, v38, v38
  v_and_b32 v38, s82, v38
  v_add_f32 v38, 0x3727c5ac, v38
  v_cvt_pk_bf16_f32 v38, v38, v38
  v_and_b32 v38, s82, v38
  v_sqrt_f32 v38, v38
  s_nop 0
  v_cvt_pk_bf16_f32 v40, v38, v38
  v_and_b32 v40, s82, v40
  v_rcp_f32 v41, v40
  v_sub_f32 v24, v24, v39
  v_cvt_pk_bf16_f32 v24, v24, v24
  v_and_b32 v24, s82, v24
  v_mul_f32 v37, v24, v41
  v_fma_f32 v38, -v37, v40, v24
  v_fma_f32 v24, v38, v41, v37
  v_cvt_pk_bf16_f32 v24, v24, v24
  v_and_b32 v24, s82, v24
  v_sub_f32 v25, v25, v39
  v_cvt_pk_bf16_f32 v25, v25, v25
  v_and_b32 v25, s82, v25
  v_mul_f32 v37, v25, v41
  v_fma_f32 v38, -v37, v40, v25
  v_fma_f32 v25, v38, v41, v37
  v_cvt_pk_bf16_f32 v25, v25, v25
  v_and_b32 v25, s82, v25
  v_sub_f32 v26, v26, v39
  v_cvt_pk_bf16_f32 v26, v26, v26
  v_and_b32 v26, s82, v26
  v_mul_f32 v37, v26, v41
  v_fma_f32 v38, -v37, v40, v26
  v_fma_f32 v26, v38, v41, v37
  v_cvt_pk_bf16_f32 v26, v26, v26
  v_and_b32 v26, s82, v26
  v_sub_f32 v27, v27, v39
  v_cvt_pk_bf16_f32 v27, v27, v27
  v_and_b32 v27, s82, v27
  v_mul_f32 v37, v27, v41
  v_fma_f32 v38, -v37, v40, v27
  v_fma_f32 v27, v38, v41, v37
  v_cvt_pk_bf16_f32 v27, v27, v27
  v_and_b32 v27, s82, v27
  v_sub_f32 v28, v28, v39
  v_cvt_pk_bf16_f32 v28, v28, v28
  v_and_b32 v28, s82, v28
  v_mul_f32 v37, v28, v41
  v_fma_f32 v38, -v37, v40, v28
  v_fma_f32 v28, v38, v41, v37
  v_cvt_pk_bf16_f32 v28, v28, v28
  v_and_b32 v28, s82, v28
  v_sub_f32 v29, v29, v39
  v_cvt_pk_bf16_f32 v29, v29, v29
  v_and_b32 v29, s82, v29
  v_mul_f32 v37, v29, v41
  v_fma_f32 v38, -v37, v40, v29
  v_fma_f32 v29, v38, v41, v37
  v_cvt_pk_bf16_f32 v29, v29, v29
  v_and_b32 v29, s82, v29
  v_sub_f32 v30, v30, v39
  v_cvt_pk_bf16_f32 v30, v30, v30
  v_and_b32 v30, s82, v30
  v_mul_f32 v37, v30, v41
  v_fma_f32 v38, -v37, v40, v30
  v_fma_f32 v30, v38, v41, v37
  v_cvt_pk_bf16_f32 v30, v30, v30
  v_and_b32 v30, s82, v30
  v_sub_f32 v31, v31, v39
  v_cvt_pk_bf16_f32 v31, v31, v31
  v_and_b32 v31, s82, v31
  v_mul_f32 v37, v31, v41
  v_fma_f32 v38, -v37, v40, v31
  v_fma_f32 v31, v38, v41, v37
  v_cvt_pk_bf16_f32 v31, v31, v31
  v_and_b32 v31, s82, v31
  v_sub_f32 v60, v60, v39
  v_cvt_pk_bf16_f32 v60, v60, v60
  v_and_b32 v60, s82, v60
  v_mul_f32 v37, v60, v41
  v_fma_f32 v38, -v37, v40, v60
  v_fma_f32 v60, v38, v41, v37
  v_cvt_pk_bf16_f32 v60, v60, v60
  v_and_b32 v60, s82, v60
  v_sub_f32 v61, v61, v39
  v_cvt_pk_bf16_f32 v61, v61, v61
  v_and_b32 v61, s82, v61
  v_mul_f32 v37, v61, v41
  v_fma_f32 v38, -v37, v40, v61
  v_fma_f32 v61, v38, v41, v37
  v_cvt_pk_bf16_f32 v61, v61, v61
  v_and_b32 v61, s82, v61
  v_add_f32 v36, v24, v25
  v_add_f32 v36, v36, v26
  v_add_f32 v36, v36, v27
  v_add_f32 v36, v36, v28
  v_add_f32 v36, v36, v29
  v_add_f32 v36, v36, v30
  v_add_f32 v36, v36, v31
  s_nop 1
  v_add_f32_dpp v36, v36, v36 quad_perm:[1,0,3,2] row_mask:0xf bank_mask:0xf
  s_nop 1
  v_add_f32_dpp v36, v36, v36 quad_perm:[2,3,0,1] row_mask:0xf bank_mask:0xf
  s_nop 1
  v_add_f32_dpp v36, v36, v36 row_ror:4 row_mask:0xf bank_mask:0xf
  s_nop 1
  v_add_f32_dpp v36, v36, v36 row_ror:8 row_mask:0xf bank_mask:0xf
  s_nop 0
  v_readlane_b32 s84, v36, 0
  v_readlane_b32 s85, v36, 16
  v_readlane_b32 s86, v36, 32
  v_readlane_b32 s87, v36, 48
  v_mov_b32 v36, s84
  v_add_f32 v36, s85, v36
  v_add_f32 v36, s86, v36
  v_add_f32 v36, s87, v36
  v_mul_f32 v36, 0x3b000000, v36
  v_sub_f32 v37, v24, v36
  v_mul_f32 v38, v37, v37
  v_sub_f32 v37, v25, v36
  v_fmac_f32 v38, v37, v37
  v_sub_f32 v37, v26, v36
  v_fmac_f32 v38, v37, v37
  v_sub_f32 v37, v27, v36
  v_fmac_f32 v38, v37, v37
  v_sub_f32 v37, v28, v36
  v_fmac_f32 v38, v37, v37
  v_sub_f32 v37, v29, v36
  v_fmac_f32 v38, v37, v37
  v_sub_f32 v37, v30, v36
  v_fmac_f32 v38, v37, v37
  v_sub_f32 v37, v31, v36
  v_fmac_f32 v38, v37, v37
  s_nop 1
  v_add_f32_dpp v38, v38, v38 quad_perm:[1,0,3,2] row_mask:0xf bank_mask:0xf
  s_nop 1
  v_add_f32_dpp v38, v38, v38 quad_perm:[2,3,0,1] row_mask:0xf bank_mask:0xf
  s_nop 1
  v_add_f32_dpp v38, v38, v38 row_ror:4 row_mask:0xf bank_mask:0xf
  s_nop 1
  v_add_f32_dpp v38, v38, v38 row_ror:8 row_mask:0xf bank_mask:0xf
  s_nop 0
  v_readlane_b32 s84, v38, 0
  v_readlane_b32 s85, v38, 16
  v_readlane_b32 s86, v38, 32
  v_readlane_b32 s87, v38, 48
  v_mov_b32 v38, s84
  v_add_f32 v38, s85, v38
  v_add_f32 v38, s86, v38
  v_add_f32 v38, s87, v38
  v_mul_f32 v38, 0x3b000000, v38
  v_cvt_pk_bf16_f32 v39, v36, v36
  v_and_b32 v39, s82, v39
  v_cvt_pk_bf16_f32 v38, v38, v38
  v_and_b32 v38, s82, v38
  v_add_f32 v38, 0x3727c5ac, v38
  v_cvt_pk_bf16_f32 v38, v38, v38
  v_and_b32 v38, s82, v38
  v_sqrt_f32 v38, v38
  s_nop 0
  v_cvt_pk_bf16_f32 v40, v38, v38
  v_and_b32 v40, s82, v40
  v_rcp_f32 v41, v40
  v_sub_f32 v60, v60, v39
  v_cvt_pk_bf16_f32 v60, v60, v60
  v_and_b32 v60, s82, v60
  v_mul_f32 v37, v60, v41
  v_fma_f32 v38, -v37, v40, v60
  v_fma_f32 v60, v38, v41, v37
  v_cvt_pk_bf16_f32 v60, v60, v60
  v_and_b32 v60, s82, v60
  v_sub_f32 v61, v61, v39
  v_cvt_pk_bf16_f32 v61, v61, v61
  v_and_b32 v61, s82, v61
  v_mul_f32 v37, v61, v41
  v_fma_f32 v38, -v37, v40, v61
  v_fma_f32 v61, v38, v41, v37
  v_cvt_pk_bf16_f32 v61, v61, v61
  v_and_b32 v61, s82, v61
  s_waitcnt vmcnt(0)
  s_mul_i32 s77, s91, 1792
  v_lshlrev_b32 v13, 5, v1
  v_add_u32 v13, s77, v13
  v_lshlrev_b32 v64, 16, v192
  v_and_b32 v65, s82, v192
  v_lshlrev_b32 v66, 16, v193
  v_and_b32 v67, s82, v193
  v_lshlrev_b32 v68, 16, v194
  v_and_b32 v69, s82, v194
  v_lshlrev_b32 v70, 16, v195
  v_and_b32 v71, s82, v195
  ds_write_b128 v13, v[64:67] offset:41984
  ds_write_b128 v13, v[68:71] offset:42000
  v_lshlrev_b32 v72, 16, v196
  v_and_b32 v73, s82, v196
  v_lshlrev_b32 v74, 16, v197
  v_and_b32 v75, s82, v197
  v_lshlrev_b32 v76, 16, v198
  v_and_b32 v77, s82, v198
  v_lshlrev_b32 v78, 16, v199
  v_and_b32 v79, s82, v199
  ds_write_b128 v13, v[72:75] offset:49408
  ds_write_b128 v13, v[76:79] offset:49424
  v_lshlrev_b32 v80, 16, v200
  v_and_b32 v81, s82, v200
  v_lshlrev_b32 v82, 16, v201
  v_and_b32 v83, s82, v201
  v_lshlrev_b32 v84, 16, v202
  v_and_b32 v85, s82, v202
  v_lshlrev_b32 v86, 16, v203
  v_and_b32 v87, s82, v203
  ds_write_b128 v13, v[80:83] offset:56832
  ds_write_b128 v13, v[84:87] offset:56848
  v_mul_u32_u24 v13, 448, v8
  v_add_u32 v13, s77, v13
  v_mov_b32 v56, 0
  v_mov_b32 v57, 0
  ds_read_b128 v[96:99], v13 offset:41984
  ds_read_b128 v[100:103], v13 offset:49408
  ds_read_b128 v[104:107], v13 offset:56832
  s_mov_b32 s88, 14
L_gelu:
  ds_read_b128 v[108:111], v13 offset:42000
  ds_read_b128 v[112:115], v13 offset:49424
  ds_read_b128 v[116:119], v13 offset:56848
  s_waitcnt lgkmcnt(3)
  v_mul_f32 v120, v60, v96
  v_mul_f32 v121, v60, v97
  v_mul_f32 v122, v60, v98
  v_mul_f32 v123, v60, v99
  v_mul_f32 v124, v61, v96
  v_mul_f32 v125, v61, v97
  v_mul_f32 v126, v61, v98
  v_mul_f32 v127, v61, v99
  v_cvt_pk_bf16_f32 v136, v120, v121
  v_cvt_pk_bf16_f32 v137, v122, v123
  v_cvt_pk_bf16_f32 v138, v124, v125
  v_cvt_pk_bf16_f32 v139, v126, v127
  v_lshlrev_b32 v120, 16, v136
  v_and_b32 v121, s82, v136
  v_lshlrev_b32 v122, 16, v137
  v_and_b32 v123, s82, v137
  v_lshlrev_b32 v124, 16, v138
  v_and_b32 v125, s82, v138
  v_lshlrev_b32 v126, 16, v139
  v_and_b32 v127, s82, v139
  v_add_f32 v120, v120, v100
  v_add_f32 v121, v121, v101
  v_add_f32 v122, v122, v102
  v_add_f32 v123, v123, v103
  v_add_f32 v124, v124, v100
  v_add_f32 v125, v125, v101
  v_add_f32 v126, v126, v102
  v_add_f32 v127, v127, v103
  v_cvt_pk_bf16_f32 v136, v120, v121
  v_cvt_pk_bf16_f32 v137, v122, v123
  v_cvt_pk_bf16_f32 v138, v124, v125
  v_cvt_pk_bf16_f32 v139, v126, v127
  v_lshlrev_b32 v120, 16, v136
  v_and_b32 v121, s82, v136
  v_lshlrev_b32 v122, 16, v137
  v_and_b32 v123, s82, v137
  v_lshlrev_b32 v124, 16, v138
  v_and_b32 v125, s82, v138
  v_lshlrev_b32 v126, 16, v139
  v_and_b32 v127, s82, v139
  v_mul_f32 v128, s89, v120
  v_mul_f32 v129, s89, v121
  v_mul_f32 v130, s89, v122
  v_mul_f32 v131, s89, v123
  v_mul_f32 v132, s89, v124
  v_mul_f32 v133, s89, v125
  v_mul_f32 v134, s89, v126
  v_mul_f32 v135, s89, v127
  v_fmaak_f32 v128, v128, v128, 0x40135761
  v_fmaak_f32 v129, v129, v129, 0x40135761
  v_fmaak_f32 v130, v130, v130, 0x40135761
  v_fmaak_f32 v131, v131, v131, 0x40135761
  v_fmaak_f32 v132, v132, v132, 0x40135761
  v_fmaak_f32 v133, v133, v133, 0x40135761
  v_fmaak_f32 v134, v134, v134, 0x40135761
  v_fmaak_f32 v135, v135, v135, 0x40135761
  v_mul_f32 v128, v128, v120
  v_mul_f32 v129, v129, v121
  v_mul_f32 v130, v130, v122
  v_mul_f32 v131, v131, v123
  v_mul_f32 v132, v132, v124
  v_mul_f32 v133, v133, v125
  v_mul_f32 v134, v134, v126
  v_mul_f32 v135, v135, v127
  v_exp_f32 v128, -v128
  v_exp_f32 v129, -v129
  v_exp_f32 v130, -v130
  v_exp_f32 v131, -v131
  v_exp_f32 v132, -v132
  v_exp_f32 v133, -v133
  v_exp_f32 v134, -v134
  v_exp_f32 v135, -v135
  v_add_f32 v128, 1.0, v128
  v_add_f32 v129, 1.0, v129
  v_add_f32 v130, 1.0, v130
  v_add_f32 v131, 1.0, v131
  v_add_f32 v132, 1.0, v132
  v_add_f32 v133, 1.0, v133
  v_add_f32 v134, 1.0, v134
  v_add_f32 v135, 1.0, v135
  v_rcp_f32 v128, v128
  v_rcp_f32 v129, v129
  v_rcp_f32 v130, v130
  v_rcp_f32 v131, v131
  v_rcp_f32 v132, v132
  v_rcp_f32 v133, v133
  v_rcp_f32 v134, v134
  v_rcp_f32 v135, v135
  v_mul_f32 v120, v120, v128
  v_mul_f32 v121, v121, v129
  v_mul_f32 v122, v122, v130
  v_mul_f32 v123, v123, v131
  v_mul_f32 v124, v124, v132
  v_mul_f32 v125, v125, v133
  v_mul_f32 v126, v126, v134
  v_mul_f32 v127, v127, v135
  v_cvt_pk_bf16_f32 v136, v120, v121
  v_cvt_pk_bf16_f32 v137, v122, v123
  v_cvt_pk_bf16_f32 v138, v124, v125
  v_cvt_pk_bf16_f32 v139, v126, v127
  v_lshlrev_b32 v120, 16, v136
  v_and_b32 v121, s82, v136
  v_lshlrev_b32 v122, 16, v137
  v_and_b32 v123, s82, v137
  v_lshlrev_b32 v124, 16, v138
  v_and_b32 v125, s82, v138
  v_lshlrev_b32 v126, 16, v139
  v_and_b32 v127, s82, v139
  v_fmac_f32 v56, v120, v104
  v_fmac_f32 v56, v121, v105
  v_fmac_f32 v56, v122, v106
  v_fmac_f32 v56, v123, v107
  v_fmac_f32 v57, v124, v104
  v_fmac_f32 v57, v125, v105
  v_fmac_f32 v57, v126, v106
  v_fmac_f32 v57, v127, v107
  ds_read_b128 v[96:99], v13 offset:42016
  ds_read_b128 v[100:103], v13 offset:49440
  ds_read_b128 v[104:107], v13 offset:56864
  s_waitcnt lgkmcnt(3)
  v_mul_f32 v120, v60, v108
  v_mul_f32 v121, v60, v109
  v_mul_f32 v122, v60, v110
  v_mul_f32 v123, v60, v111
  v_mul_f32 v124, v61, v108
  v_mul_f32 v125, v61, v109
  v_mul_f32 v126, v61, v110
  v_mul_f32 v127, v61, v111
  v_cvt_pk_bf16_f32 v136, v120, v121
  v_cvt_pk_bf16_f32 v137, v122, v123
  v_cvt_pk_bf16_f32 v138, v124, v125
  v_cvt_pk_bf16_f32 v139, v126, v127
  v_lshlrev_b32 v120, 16, v136
  v_and_b32 v121, s82, v136
  v_lshlrev_b32 v122, 16, v137
  v_and_b32 v123, s82, v137
  v_lshlrev_b32 v124, 16, v138
  v_and_b32 v125, s82, v138
  v_lshlrev_b32 v126, 16, v139
  v_and_b32 v127, s82, v139
  v_add_f32 v120, v120, v112
  v_add_f32 v121, v121, v113
  v_add_f32 v122, v122, v114
  v_add_f32 v123, v123, v115
  v_add_f32 v124, v124, v112
  v_add_f32 v125, v125, v113
  v_add_f32 v126, v126, v114
  v_add_f32 v127, v127, v115
  v_cvt_pk_bf16_f32 v136, v120, v121
  v_cvt_pk_bf16_f32 v137, v122, v123
  v_cvt_pk_bf16_f32 v138, v124, v125
  v_cvt_pk_bf16_f32 v139, v126, v127
  v_lshlrev_b32 v120, 16, v136
  v_and_b32 v121, s82, v136
  v_lshlrev_b32 v122, 16, v137
  v_and_b32 v123, s82, v137
  v_lshlrev_b32 v124, 16, v138
  v_and_b32 v125, s82, v138
  v_lshlrev_b32 v126, 16, v139
  v_and_b32 v127, s82, v139
  v_mul_f32 v128, s89, v120
  v_mul_f32 v129, s89, v121
  v_mul_f32 v130, s89, v122
  v_mul_f32 v131, s89, v123
  v_mul_f32 v132, s89, v124
  v_mul_f32 v133, s89, v125
  v_mul_f32 v134, s89, v126
  v_mul_f32 v135, s89, v127
  v_fmaak_f32 v128, v128, v128, 0x40135761
  v_fmaak_f32 v129, v129, v129, 0x40135761
  v_fmaak_f32 v130, v130, v130, 0x40135761
  v_fmaak_f32 v131, v131, v131, 0x40135761
  v_fmaak_f32 v132, v132, v132, 0x40135761
  v_fmaak_f32 v133, v133, v133, 0x40135761
  v_fmaak_f32 v134, v134, v134, 0x40135761
  v_fmaak_f32 v135, v135, v135, 0x40135761
  v_mul_f32 v128, v128, v120
  v_mul_f32 v129, v129, v121
  v_mul_f32 v130, v130, v122
  v_mul_f32 v131, v131, v123
  v_mul_f32 v132, v132, v124
  v_mul_f32 v133, v133, v125
  v_mul_f32 v134, v134, v126
  v_mul_f32 v135, v135, v127
  v_exp_f32 v128, -v128
  v_exp_f32 v129, -v129
  v_exp_f32 v130, -v130
  v_exp_f32 v131, -v131
  v_exp_f32 v132, -v132
  v_exp_f32 v133, -v133
  v_exp_f32 v134, -v134
  v_exp_f32 v135, -v135
  v_add_f32 v128, 1.0, v128
  v_add_f32 v129, 1.0, v129
  v_add_f32 v130, 1.0, v130
  v_add_f32 v131, 1.0, v131
  v_add_f32 v132, 1.0, v132
  v_add_f32 v133, 1.0, v133
  v_add_f32 v134, 1.0, v134
  v_add_f32 v135, 1.0, v135
  v_rcp_f32 v128, v128
  v_rcp_f32 v129, v129
  v_rcp_f32 v130, v130
  v_rcp_f32 v131, v131
  v_rcp_f32 v132, v132
  v_rcp_f32 v133, v133
  v_rcp_f32 v134, v134
  v_rcp_f32 v135, v135
  v_mul_f32 v120, v120, v128
  v_mul_f32 v121, v121, v129
  v_mul_f32 v122, v122, v130
  v_mul_f32 v123, v123, v131
  v_mul_f32 v124, v124, v132
  v_mul_f32 v125, v125, v133
  v_mul_f32 v126, v126, v134
  v_mul_f32 v127, v127, v135
  v_cvt_pk_bf16_f32 v136, v120, v121
  v_cvt_pk_bf16_f32 v137, v122, v123
  v_cvt_pk_bf16_f32 v138, v124, v125
  v_cvt_pk_bf16_f32 v139, v126, v127
  v_lshlrev_b32 v120, 16, v136
  v_and_b32 v121, s82, v136
  v_lshlrev_b32 v122, 16, v137
  v_and_b32 v123, s82, v137
  v_lshlrev_b32 v124, 16, v138
  v_and_b32 v125, s82, v138
  v_lshlrev_b32 v126, 16, v139
  v_and_b32 v127, s82, v139
  v_fmac_f32 v56, v120, v116
  v_fmac_f32 v56, v121, v117
  v_fmac_f32 v56, v122, v118
  v_fmac_f32 v56, v123, v119
  v_fmac_f32 v57, v124, v116
  v_fmac_f32 v57, v125, v117
  v_fmac_f32 v57, v126, v118
  v_fmac_f32 v57, v127, v119
  v_add_u32 v13, 32, v13
  s_sub_u32 s88, s88, 1
  s_cmp_lg_u32 s88, 0
  s_cbranch_scc1 L_gelu
  v_permlane16_swap_b32 v56, v57
  v_add_f32 v56, v56, v57
  v_mov_b32 v63, v56
  s_nop 1
  v_permlane32_swap_b32 v63, v56
  v_add_f32 v56, v56, v63
  s_lshl_b32 s78, s91, 2
  v_add_u32 v63, s78, v3
  s_mov_b32 exec_hi, 0
  ds_write_b32 v63, v56 offset:41280
  s_mov_b64 exec, -1
L_nogelu:
  s_setprio 3
  s_lshl_b32 s78, s73, 17
  s_add_u32 s44, s12, s78
  s_addc_u32 s45, s13, 0
  s_and_b32 s45, s45, 0xffff
  s_mov_b32 s46, 131072
  s_mov_b32 s47, 0x00020000
  s_mul_i32 s99, s72, 4
  s_and_b32 s99, s99, 31
  v_and_b32 v11, 13, v9
  v_and_b32 v63, 2, v8
  v_add3_u32 v11, v11, v63, s99
  v_and_b32 v11, 31, v11
  v_and_b32 v63, 1, v8
  v_lshl_add_u32 v11, v11, 1, v63
  v_bfe_u32 v63, v9, 1, 1
  v_lshl_add_u32 v11, v11, 1, v63
  v_lshlrev_b32 v11, 2, v11
  v_xor_b32 v12, 256, v11
  s_lshl_b32 s99, s99, 12
  v_lshlrev_b32 v10, 10, v8
  v_lshl_add_u32 v10, v9, 4, v10
  s_lshl_b32 s79, s91, 8
  v_add_u32 v10, s79, v10
  v_lshrrev_b32 v13, 2, v9
  v_lshlrev_b32 v13, 13, v13
  v_and_b32 v63, 3, v9
  v_lshl_add_u32 v13, v63, 4, v13
  v_and_b32 v63, 1, v8
  v_lshl_add_u32 v13, v63, 6, v13
  s_lshr_b32 s77, s73, 3
  s_lshl_b32 s77, s77, 4
  s_lshr_b32 s78, s2, 7
  s_lshl_b32 s78, s78, 3
  s_and_b32 s36, s73, 7
  s_add_u32 s36, s36, s77
  s_add_u32 s36, s36, s78
  s_and_b32 s77, s72, 3
  s_lshl_b32 s98, s77, 17
  s_lshl_b32 s78, s91, 15
  s_add_u32 s98, s98, s78
  s_lshl_b32 s78, s36, 7
  s_add_u32 s98, s98, s78
  s_lshl_b32 s77, s77, 10
  s_lshl_b32 s36, s36, 4
  s_add_u32 s36, s36, s77
  s_add_u32 s36, s36, 1048576
  s_waitcnt vmcnt(1)
  buffer_load_dwordx4 v[96:99], v10, s[44:47], s99 offen
  s_add_u32 s99, s99, 4096
  s_and_b32 s99, s99, 0x1ffff
  s_waitcnt vmcnt(1)
  buffer_load_dwordx4 v[104:107], v10, s[44:47], s99 offen
  s_add_u32 s99, s99, 4096
  s_and_b32 s99, s99, 0x1ffff
  s_waitcnt vmcnt(1)
  buffer_load_dwordx4 v[112:115], v10, s[44:47], s99 offen
  s_add_u32 s99, s99, 4096
  s_and_b32 s99, s99, 0x1ffff
  s_waitcnt vmcnt(1)
  buffer_load_dwordx4 v[120:123], v10, s[44:47], s99 offen
  s_add_u32 s99, s99, 4096
  s_and_b32 s99, s99, 0x1ffff
  s_waitcnt vmcnt(1)
  buffer_load_dwordx4 v[128:131], v10, s[44:47], s99 offen
  s_add_u32 s99, s99, 4096
  s_and_b32 s99, s99, 0x1ffff
  s_waitcnt vmcnt(1)
  buffer_load_dwordx4 v[136:139], v10, s[44:47], s99 offen
  s_add_u32 s99, s99, 4096
  s_and_b32 s99, s99, 0x1ffff
  s_waitcnt vmcnt(1)
  buffer_load_dwordx4 v[144:147], v10, s[44:47], s99 offen
  s_add_u32 s99, s99, 4096
  s_and_b32 s99, s99, 0x1ffff
  s_waitcnt vmcnt(1)
  buffer_load_dwordx4 v[152:155], v10, s[44:47], s99 offen
  s_add_u32 s99, s99, 4096
  s_and_b32 s99, s99, 0x1ffff
  s_waitcnt vmcnt(1)
  buffer_load_dwordx4 v[160:163], v10, s[44:47], s99 offen
  s_add_u32 s99, s99, 4096
  s_and_b32 s99, s99, 0x1ffff
  s_waitcnt vmcnt(1)
  buffer_load_dwordx4 v[168:171], v10, s[44:47], s99 offen
  s_add_u32 s99, s99, 4096
  s_and_b32 s99, s99, 0x1ffff
  s_waitcnt vmcnt(1)
  buffer_load_dwordx4 v[176:179], v10, s[44:47], s99 offen
  s_add_u32 s99, s99, 4096
  s_and_b32 s99, s99, 0x1ffff
  s_waitcnt vmcnt(1)
  buffer_load_dwordx4 v[184:187], v10, s[44:47], s99 offen
  s_add_u32 s99, s99, 4096
  s_and_b32 s99, s99, 0x1ffff
  s_waitcnt vmcnt(1)
  buffer_load_dwordx4 v[192:195], v10, s[44:47], s99 offen
  s_add_u32 s99, s99, 4096
  s_and_b32 s99, s99, 0x1ffff
  s_waitcnt vmcnt(1)
  buffer_load_dwordx4 v[200:203], v10, s[44:47], s99 offen
  s_add_u32 s99, s99, 4096
  s_and_b32 s99, s99, 0x1ffff
  s_waitcnt vmcnt(1)
  buffer_load_dwordx4 v[208:211], v10, s[44:47], s99 offen
  s_add_u32 s99, s99, 4096
  s_and_b32 s99, s99, 0x1ffff
  s_waitcnt vmcnt(1)
  buffer_load_dwordx4 v[216:219], v10, s[44:47], s99 offen
  s_add_u32 s99, s99, 4096
  s_and_b32 s99, s99, 0x1ffff
  s_waitcnt vmcnt(1)
  buffer_load_dwordx4 v[100:103], v10, s[44:47], s99 offen
  s_add_u32 s99, s99, 4096
  s_and_b32 s99, s99, 0x1ffff
  s_waitcnt vmcnt(1)
  buffer_load_dwordx4 v[108:111], v10, s[44:47], s99 offen
  s_add_u32 s99, s99, 4096
  s_and_b32 s99, s99, 0x1ffff
  s_waitcnt vmcnt(1)
  buffer_load_dwordx4 v[116:119], v10, s[44:47], s99 offen
  s_add_u32 s99, s99, 4096
  s_and_b32 s99, s99, 0x1ffff
  s_waitcnt vmcnt(1)
  buffer_load_dwordx4 v[124:127], v10, s[44:47], s99 offen
  s_add_u32 s99, s99, 4096
  s_and_b32 s99, s99, 0x1ffff
  s_waitcnt vmcnt(1)
  buffer_load_dwordx4 v[132:135], v10, s[44:47], s99 offen
  s_add_u32 s99, s99, 4096
  s_and_b32 s99, s99, 0x1ffff
  s_waitcnt vmcnt(1)
  buffer_load_dwordx4 v[140:143], v10, s[44:47], s99 offen
  s_add_u32 s99, s99, 4096
  s_and_b32 s99, s99, 0x1ffff
  s_waitcnt vmcnt(1)
  buffer_load_dwordx4 v[148:151], v10, s[44:47], s99 offen
  s_add_u32 s99, s99, 4096
  s_and_b32 s99, s99, 0x1ffff
  s_waitcnt vmcnt(1)
  buffer_load_dwordx4 v[156:159], v10, s[44:47], s99 offen
  s_add_u32 s99, s99, 4096
  s_and_b32 s99, s99, 0x1ffff
  s_waitcnt vmcnt(1)
  buffer_load_dwordx4 v[164:167], v10, s[44:47], s99 offen
  s_add_u32 s99, s99, 4096
  s_and_b32 s99, s99, 0x1ffff
  s_waitcnt vmcnt(1)
  buffer_load_dwordx4 v[172:175], v10, s[44:47], s99 offen
  s_add_u32 s99, s99, 4096
  s_and_b32 s99, s99, 0x1ffff
  s_waitcnt vmcnt(1)
  buffer_load_dwordx4 v[180:183], v10, s[44:47], s99 offen
  s_add_u32 s99, s99, 4096
  s_and_b32 s99, s99, 0x1ffff
  s_waitcnt vmcnt(1)
  buffer_load_dwordx4 v[188:191], v10, s[44:47], s99 offen
  s_add_u32 s99, s99, 4096
  s_and_b32 s99, s99, 0x1ffff
  s_waitcnt vmcnt(1)
  buffer_load_dwordx4 v[196:199], v10, s[44:47], s99 offen
  s_add_u32 s99, s99, 4096
  s_and_b32 s99, s99, 0x1ffff
  s_waitcnt vmcnt(1)
  buffer_load_dwordx4 v[204:207], v10, s[44:47], s99 offen
  s_add_u32 s99, s99, 4096
  s_and_b32 s99, s99, 0x1ffff
  s_waitcnt vmcnt(1)
  buffer_load_dwordx4 v[212:215], v10, s[44:47], s99 offen
  s_add_u32 s99, s99, 4096
  s_and_b32 s99, s99, 0x1ffff
  s_waitcnt vmcnt(1)
  buffer_load_dwordx4 v[220:223], v10, s[44:47], s99 offen
  s_cmp_lg_u32 s74, 0
  s_cbranch_scc1 L_notag
  s_mov_b64 exec, 1
  global_load_dword v18, v14, s[26:27] sc1
  s_waitcnt vmcnt(0)
  v_cmp_ne_u32 vcc, 0, v18
  s_cbranch_vccnz L_havetag
  global_atomic_cmpswap v18, v14, v[16:17], s[26:27] sc0 sc1
  s_waitcnt vmcnt(0)
  v_cmp_ne_u32 vcc, 0, v18
  s_nop 1
  v_cndmask_b32 v18, v16, v18, vcc
L_havetag:
  ds_write_b32 v14, v18 offset:41920
  s_mov_b64 exec, -1
L_notag:
  s_load_dword s90, s[22:23], 0
  s_mov_b32 s37, 0xff
  s_waitcnt vmcnt(0) lgkmcnt(0)
  s_mov_b32 s38, 0
  s_setprio 0
  v_mov_b32 v64, v96
  v_mov_b32 v65, v100
  v_mov_b32 v66, v104
  v_mov_b32 v67, v108
  v_mov_b32 v68, v112
  v_mov_b32 v69, v116
  v_mov_b32 v70, v120
  v_mov_b32 v71, v124
  v_mov_b32 v72, v97
  v_mov_b32 v73, v101
  v_mov_b32 v74, v105
  v_mov_b32 v75, v109
  v_mov_b32 v76, v113
  v_mov_b32 v77, v117
  v_mov_b32 v78, v121
  v_mov_b32 v79, v125
  v_mov_b32 v80, v98
  v_mov_b32 v81, v102
  v_mov_b32 v82, v106
  v_mov_b32 v83, v110
  v_mov_b32 v84, v114
  v_mov_b32 v85, v118
  v_mov_b32 v86, v122
  v_mov_b32 v87, v126
  v_mov_b32 v88, v99
  v_mov_b32 v89, v103
  v_mov_b32 v90, v107
  v_mov_b32 v91, v111
  v_mov_b32 v92, v115
  v_mov_b32 v93, v119
  v_mov_b32 v94, v123
  v_mov_b32 v95, v127
  v_mov_b32 v96, v128
  v_mov_b32 v97, v132
  v_mov_b32 v98, v136
  v_mov_b32 v99, v140
  v_mov_b32 v100, v144
  v_mov_b32 v101, v148
  v_mov_b32 v102, v152
  v_mov_b32 v103, v156
  v_mov_b32 v104, v129
  v_mov_b32 v105, v133
  v_mov_b32 v106, v137
  v_mov_b32 v107, v141
  v_mov_b32 v108, v145
  v_mov_b32 v109, v149
  v_mov_b32 v110, v153
  v_mov_b32 v111, v157
  v_mov_b32 v112, v130
  v_mov_b32 v113, v134
  v_mov_b32 v114, v138
  v_mov_b32 v115, v142
  v_mov_b32 v116, v146
  v_mov_b32 v117, v150
  v_mov_b32 v118, v154
  v_mov_b32 v119, v158
  v_mov_b32 v120, v131
  v_mov_b32 v121, v135
  v_mov_b32 v122, v139
  v_mov_b32 v123, v143
  v_mov_b32 v124, v147
  v_mov_b32 v125, v151
  v_mov_b32 v126, v155
  v_mov_b32 v127, v159
  v_mov_b32 v128, v160
  v_mov_b32 v129, v164
  v_mov_b32 v130, v168
  v_mov_b32 v131, v172
  v_mov_b32 v132, v176
  v_mov_b32 v133, v180
  v_mov_b32 v134, v184
  v_mov_b32 v135, v188
  v_mov_b32 v136, v161
  v_mov_b32 v137, v165
  v_mov_b32 v138, v169
  v_mov_b32 v139, v173
  v_mov_b32 v140, v177
  v_mov_b32 v141, v181
  v_mov_b32 v142, v185
  v_mov_b32 v143, v189
  v_mov_b32 v144, v162
  v_mov_b32 v145, v166
  v_mov_b32 v146, v170
  v_mov_b32 v147, v174
  v_mov_b32 v148, v178
  v_mov_b32 v149, v182
  v_mov_b32 v150, v186
  v_mov_b32 v151, v190
  v_mov_b32 v152, v163
  v_mov_b32 v153, v167
  v_mov_b32 v154, v171
  v_mov_b32 v155, v175
  v_mov_b32 v156, v179
  v_mov_b32 v157, v183
  v_mov_b32 v158, v187
  v_mov_b32 v159, v191
  v_mov_b32 v160, v192
  v_mov_b32 v161, v196
  v_mov_b32 v162, v200
  v_mov_b32 v163, v204
  v_mov_b32 v164, v208
  v_mov_b32 v165, v212
  v_mov_b32 v166, v216
  v_mov_b32 v167, v220
  v_mov_b32 v168, v193
  v_mov_b32 v169, v197
  v_mov_b32 v170, v201
  v_mov_b32 v171, v205
  v_mov_b32 v172, v209
  v_mov_b32 v173, v213
  v_mov_b32 v174, v217
  v_mov_b32 v175, v221
  v_mov_b32 v176, v194
  v_mov_b32 v177, v198
  v_mov_b32 v178, v202
  v_mov_b32 v179, v206
  v_mov_b32 v180, v210
  v_mov_b32 v181, v214
  v_mov_b32 v182, v218
  v_mov_b32 v183, v222
  v_mov_b32 v184, v195
  v_mov_b32 v185, v199
  v_mov_b32 v186, v203
  v_mov_b32 v187, v207
  v_mov_b32 v188, v211
  v_mov_b32 v189, v215
  v_mov_b32 v190, v219
  v_mov_b32 v191, v223
  v_mov_b32 v208, 0
  v_mov_b32 v209, 0
  v_mov_b32 v210, 0
  v_mov_b32 v211, 0
  v_mov_b32 v212, 0
  v_mov_b32 v213, 0
  v_mov_b32 v214, 0
  v_mov_b32 v215, 0
  v_mov_b32 v216, 0
  v_mov_b32 v217, 0
  v_mov_b32 v218, 0
  v_mov_b32 v219, 0
  v_mov_b32 v220, 0
  v_mov_b32 v221, 0
  v_mov_b32 v222, 0
  v_mov_b32 v223, 0
  v_and_b32 v240, 1, v1
  v_mul_u32_u24 v240, 0x5555, v240
  v_add_u32 v240, 0x8888, v240
  s_setprio 3
L_hloop:
  s_barrier
  ds_read2st64_b32 v[32:33], v11 offset0:144 offset1:146
  ds_read2st64_b32 v[34:35], v11 offset0:148 offset1:150
  ds_read2st64_b32 v[36:37], v12 offset0:144 offset1:146
  ds_read2st64_b32 v[38:39], v12 offset0:148 offset1:150
  s_cmp_eq_u32 s38, 0
  s_cbranch_scc1 L_first
L_gemv:
  s_waitcnt lgkmcnt(0)
  v_mul_f32 v52, v200, v32
  v_mul_f32 v53, v200, v36
  v_fmac_f32 v52, v201, v33
  v_fmac_f32 v53, v201, v37
  v_fmac_f32 v52, v202, v34
  v_fmac_f32 v53, v202, v38
  v_fmac_f32 v52, v203, v35
  v_fmac_f32 v53, v203, v39
  v_cvt_pk_bf16_f32 v52, v52, v53
  s_nop 1
  v_mov_b32_dpp v224, v52 row_newbcast:0 row_mask:0xf bank_mask:0xf
  v_mov_b32_dpp v225, v52 row_newbcast:1 row_mask:0xf bank_mask:0xf
  v_mov_b32_dpp v226, v52 row_newbcast:2 row_mask:0xf bank_mask:0xf
  v_mov_b32_dpp v227, v52 row_newbcast:3 row_mask:0xf bank_mask:0xf
  v_mov_b32_dpp v228, v52 row_newbcast:4 row_mask:0xf bank_mask:0xf
  v_mov_b32_dpp v229, v52 row_newbcast:5 row_mask:0xf bank_mask:0xf
  v_mov_b32_dpp v230, v52 row_newbcast:6 row_mask:0xf bank_mask:0xf
  v_mov_b32_dpp v231, v52 row_newbcast:7 row_mask:0xf bank_mask:0xf
  v_mov_b32_dpp v232, v52 row_newbcast:8 row_mask:0xf bank_mask:0xf
  v_mov_b32_dpp v233, v52 row_newbcast:9 row_mask:0xf bank_mask:0xf
  v_mov_b32_dpp v234, v52 row_newbcast:10 row_mask:0xf bank_mask:0xf
  v_mov_b32_dpp v235, v52 row_newbcast:11 row_mask:0xf bank_mask:0xf
  v_mov_b32_dpp v236, v52 row_newbcast:12 row_mask:0xf bank_mask:0xf
  v_mov_b32_dpp v237, v52 row_newbcast:13 row_mask:0xf bank_mask:0xf
  v_mov_b32_dpp v238, v52 row_newbcast:14 row_mask:0xf bank_mask:0xf
  v_mov_b32_dpp v239, v52 row_newbcast:15 row_mask:0xf bank_mask:0xf
  v_smfmac_f32_16x16x64_bf16 v[208:211], v[224:227], v[64:71], v240
  v_smfmac_f32_16x16x64_bf16 v[212:215], v[224:227], v[72:79], v240
  v_smfmac_f32_16x16x64_bf16 v[216:219], v[224:227], v[80:87], v240
  v_smfmac_f32_16x16x64_bf16 v[220:223], v[224:227], v[88:95], v240
  v_smfmac_f32_16x16x64_bf16 v[208:211], v[228:231], v[96:103], v240
  v_smfmac_f32_16x16x64_bf16 v[212:215], v[228:231], v[104:111], v240
  v_smfmac_f32_16x16x64_bf16 v[216:219], v[228:231], v[112:119], v240
  v_smfmac_f32_16x16x64_bf16 v[220:223], v[228:231], v[120:127], v240
  v_smfmac_f32_16x16x64_bf16 v[208:211], v[232:235], v[128:135], v240
  v_smfmac_f32_16x16x64_bf16 v[212:215], v[232:235], v[136:143], v240
  v_smfmac_f32_16x16x64_bf16 v[216:219], v[232:235], v[144:151], v240
  v_smfmac_f32_16x16x64_bf16 v[220:223], v[232:235], v[152:159], v240
  v_smfmac_f32_16x16x64_bf16 v[208:211], v[236:239], v[160:167], v240
  v_smfmac_f32_16x16x64_bf16 v[212:215], v[236:239], v[168:175], v240
  v_smfmac_f32_16x16x64_bf16 v[216:219], v[236:239], v[176:183], v240
  v_smfmac_f32_16x16x64_bf16 v[220:223], v[236:239], v[184:191], v240
  s_mov_b64 exec, 0xffff
  s_nop 3
  v_bfi_b32 v192, s37, v40, v208
  v_bfi_b32 v193, s37, v41, v209
  v_bfi_b32 v194, s37, v42, v212
  v_bfi_b32 v195, s37, v43, v213
  s_mov_b32 exec_lo, 0xffff0000
  v_bfi_b32 v192, s37, v40, v216
  v_bfi_b32 v193, s37, v41, v217
  v_bfi_b32 v194, s37, v42, v220
  v_bfi_b32 v195, s37, v43, v221
  s_mov_b32 exec_lo, -1
  buffer_store_dwordx4 v[192:195], v13, s[68:71], s98 offen sc0 sc1
  s_cmp_eq_u32 s38, 0
  s_cbranch_scc1 L_second
  s_endpgm
L_first:
  ds_read_b128 v[16:19], v14 offset:40960
  ds_read_b128 v[20:23], v14 offset:40976
  ds_read_b128 v[24:27], v14 offset:40992
  ds_read_b128 v[28:31], v14 offset:41008
  ds_read_b32 v40, v14 offset:41920
  s_waitcnt lgkmcnt(0)
  v_lshrrev_b32 v41, 8, v40
  v_lshrrev_b32 v42, 16, v40
  v_lshrrev_b32 v43, 24, v40
  v_max3_f32 v48, v16, v20, v24
  v_max_f32 v48, v48, v28
  v_sub_f32 v16, v16, v48
  v_sub_f32 v20, v20, v48
  v_sub_f32 v24, v24, v48
  v_sub_f32 v28, v28, v48
  v_mul_f32 v16, s81, v16
  v_mul_f32 v20, s81, v20
  v_mul_f32 v24, s81, v24
  v_mul_f32 v28, s81, v28
  v_exp_f32 v16, v16
  v_exp_f32 v20, v20
  v_exp_f32 v24, v24
  v_exp_f32 v28, v28
  v_mul_f32 v50, v16, v17
  v_fmac_f32 v50, v20, v21
  v_fmac_f32 v50, v24, v25
  v_fmac_f32 v50, v28, v29
  v_rcp_f32 v63, v50
  s_nop 0
  v_mul_f32 v200, v16, v63
  v_mul_f32 v201, v20, v63
  v_mul_f32 v202, v24, v63
  v_mul_f32 v203, v28, v63
  v_max3_f32 v49, v18, v22, v26
  v_max_f32 v49, v49, v30
  v_sub_f32 v18, v18, v49
  v_sub_f32 v22, v22, v49
  v_sub_f32 v26, v26, v49
  v_sub_f32 v30, v30, v49
  v_mul_f32 v18, s81, v18
  v_mul_f32 v22, s81, v22
  v_mul_f32 v26, s81, v26
  v_mul_f32 v30, s81, v30
  v_exp_f32 v18, v18
  v_exp_f32 v22, v22
  v_exp_f32 v26, v26
  v_exp_f32 v30, v30
  v_mul_f32 v51, v18, v19
  v_fmac_f32 v51, v22, v23
  v_fmac_f32 v51, v26, v27
  v_fmac_f32 v51, v30, v31
  v_rcp_f32 v63, v51
  s_nop 0
  v_mul_f32 v44, v18, v63
  v_mul_f32 v45, v22, v63
  v_mul_f32 v46, v26, v63
  v_mul_f32 v47, v30, v63
  s_cmp_lg_u32 s74, 0
  s_cbranch_scc1 L_gemv
  v_cmp_eq_u32 vcc, 0, v1
  s_nop 1
  v_cndmask_b32 v56, v49, v48, vcc
  v_cndmask_b32 v57, v51, v50, vcc
  v_bfi_b32 v56, s37, v40, v56
  v_bfi_b32 v57, s37, v41, v57
  v_mov_b32 v58, v42
  v_mov_b32 v59, v43
  v_lshlrev_b32 v63, 12, v1
  s_mov_b64 exec, 3
  buffer_store_dwordx4 v[56:59], v63, s[68:71], s36 offen sc1
  s_mov_b64 exec, -1
  s_branch L_gemv
L_second:
  s_add_u32 s98, s98, 524288
  s_mov_b64 exec, -1
  s_mov_b32 s38, 1
  v_mov_b32 v200, v44
  v_mov_b32 v201, v45
  v_mov_b32 v202, v46
  v_mov_b32 v203, v47
  v_mov_b32 v208, 0
  v_mov_b32 v209, 0
  v_mov_b32 v210, 0
  v_mov_b32 v211, 0
  v_mov_b32 v212, 0
  v_mov_b32 v213, 0
  v_mov_b32 v214, 0
  v_mov_b32 v215, 0
  v_mov_b32 v216, 0
  v_mov_b32 v217, 0
  v_mov_b32 v218, 0
  v_mov_b32 v219, 0
  v_mov_b32 v220, 0
  v_mov_b32 v221, 0
  v_mov_b32 v222, 0
  v_mov_b32 v223, 0
  v_add_u32 v11, 2048, v11
  v_add_u32 v12, 2048, v12
  s_cmp_lg_u32 s101, 0
  s_cbranch_scc1 L_hloop
  s_cmp_lg_u32 s74, 1
  s_cbranch_scc1 L_hloop
  s_setprio 0
  ds_read_b128 v[16:19], v3 offset:41280
  s_waitcnt lgkmcnt(0)
  v_add_f32 v16, v16, v17
  v_add_f32 v16, v16, v18
  v_add_f32 v16, v16, v19
  v_cvt_pk_bf16_f32 v16, v16, v16
  v_and_b32 v16, s82, v16
  s_lshl_b32 s77, s90, 16
  v_add_f32 v16, s77, v16
  v_cvt_pk_bf16_f32 v16, v16, v16
  v_and_b32 v16, s82, v16
  v_mul_f32 v17, s83, v16
  v_exp_f32 v17, v17
  s_nop 0
  v_add_f32 v17, 1.0, v17
  v_rcp_f32 v17, v17
  s_nop 0
  v_mul_f32 v16, v16, v17
  v_cvt_pk_bf16_f32 v16, v16, v16
  v_and_b32 v16, s82, v16
  v_lshlrev_b32 v63, 2, v1
  s_mov_b32 exec_hi, 0
  ds_write_b32 v63, v16 offset:41792
  ds_write_b32 v14, v14 offset:41924
  s_mov_b64 exec, -1
  s_and_b32 s78, s92, 0x1c00
  s_add_u32 s78, s78, 1048576
  s_mov_b32 s88, 200000
L_mlpoll:
  buffer_load_dwordx4 v[16:19], v3, s[68:71], s78 offen sc1
  s_sub_u32 s88, s88, 1
  s_cbranch_scc1 L_mlok
  s_waitcnt vmcnt(0)
  v_xor_b32 v20, v16, v40
  v_bitop3_b32 v20, v20, v17, v41 bitop3:0xf6
  v_bitop3_b32 v20, v20, v18, v42 bitop3:0xf6
  v_bitop3_b32 v20, v20, v19, v43 bitop3:0xf6
  v_and_b32 v20, s37, v20
  v_cmp_ne_u32 vcc, 0, v20
  s_cbranch_vccnz L_mlpoll
L_mlok:
  s_waitcnt vmcnt(0)
  v_and_b32 v16, s82, v16
  v_and_b32 v17, 0xffffff00, v17
  s_nop 0
  v_max_f32_dpp v18, v16, v16 row_ror:8 row_mask:0xf bank_mask:0xf
  v_sub_f32 v16, v16, v18
  v_mul_f32 v16, s81, v16
  v_exp_f32 v16, v16
  s_nop 0
  v_mul_f32 v16, v16, v17
  s_nop 1
  v_add_f32_dpp v18, v16, v16 row_ror:8 row_mask:0xf bank_mask:0xf
  v_rcp_f32 v18, v18
  s_nop 0
  v_mul_f32 v16, v16, v18
  v_and_b32 v63, 7, v1
  v_lshlrev_b32 v63, 5, v63
  v_lshrrev_b32 v17, 3, v1
  v_lshl_add_u32 v63, v17, 2, v63
  ds_write_b32 v63, v16 offset:41024
  s_waitcnt lgkmcnt(0)
  s_setprio 3
  s_branch L_hloop
L_stream:
  v_lshlrev_b32 v2, 6, v8
  v_bfe_u32 v60, v1, 2, 2
  v_lshl_add_u32 v2, v60, 8, v2
  v_and_b32 v63, 3, v1
  v_lshl_add_u32 v2, v63, 4, v2
  s_lshl_b32 s75, s91, 12
  s_lshr_b32 s79, s2, 7
  s_lshl_b32 s79, s79, 16
  s_add_u32 s75, s75, s79
  s_and_b32 s77, s2, 127
  s_lshl_b32 s77, s77, 21
  s_mov_b32 s76, s75
  s_waitcnt lgkmcnt(0)
  s_add_u32 s32, s6, s77
  s_addc_u32 s33, s7, 0
  s_and_b32 s33, s33, 0xffff
  s_mov_b32 s34, 270532608
  s_mov_b32 s35, 0x00020000
  buffer_load_dwordx4 v[192:195], v2, s[32:35], s75 offen offset:0 nt
  buffer_load_dwordx4 v[196:199], v2, s[32:35], s75 offen offset:1024 nt
  buffer_load_dwordx4 v[200:203], v2, s[32:35], s75 offen offset:2048 nt
  buffer_load_dwordx4 v[204:207], v2, s[32:35], s75 offen offset:3072 nt
  s_add_u32 s75, s75, 16384
  buffer_load_dwordx4 v[208:211], v2, s[32:35], s75 offen offset:0 nt
  buffer_load_dwordx4 v[212:215], v2, s[32:35], s75 offen offset:1024 nt
  s_waitcnt vmcnt(5)
  buffer_load_dwordx4 v[216:219], v2, s[32:35], s75 offen offset:2048 nt
  s_waitcnt vmcnt(5)
  buffer_load_dwordx4 v[220:223], v2, s[32:35], s75 offen offset:3072 nt
  s_add_u32 s75, s75, 16384
  s_waitcnt vmcnt(5)
  buffer_load_dwordx4 v[224:227], v2, s[32:35], s75 offen offset:0 nt
  s_waitcnt vmcnt(5)
  buffer_load_dwordx4 v[228:231], v2, s[32:35], s75 offen offset:1024 nt
  s_waitcnt vmcnt(5)
  buffer_load_dwordx4 v[232:235], v2, s[32:35], s75 offen offset:2048 nt
  s_waitcnt vmcnt(5)
  buffer_load_dwordx4 v[236:239], v2, s[32:35], s75 offen offset:3072 nt
  s_add_u32 s75, s75, 16384
  s_waitcnt vmcnt(5)
  buffer_load_dwordx4 v[240:243], v2, s[32:35], s75 offen offset:0 nt
  s_waitcnt vmcnt(5)
  buffer_load_dwordx4 v[244:247], v2, s[32:35], s75 offen offset:1024 nt
  s_waitcnt vmcnt(5)
  buffer_load_dwordx4 v[248:251], v2, s[32:35], s75 offen offset:2048 nt
  s_waitcnt vmcnt(5)
  buffer_load_dwordx4 v[252:255], v2, s[32:35], s75 offen offset:3072 nt
  s_add_u32 s75, s75, 81920
  s_waitcnt vmcnt(5)
  buffer_load_dwordx4 v[64:67], v2, s[32:35], s75 offen offset:0 nt
  s_waitcnt vmcnt(5)
  buffer_load_dwordx4 v[68:71], v2, s[32:35], s75 offen offset:1024 nt
  s_waitcnt vmcnt(5)
  buffer_load_dwordx4 v[72:75], v2, s[32:35], s75 offen offset:2048 nt
  s_waitcnt vmcnt(5)
  buffer_load_dwordx4 v[76:79], v2, s[32:35], s75 offen offset:3072 nt
  s_add_u32 s75, s75, 16384
  s_waitcnt vmcnt(5)
  buffer_load_dwordx4 v[80:83], v2, s[32:35], s75 offen offset:0 nt
  s_waitcnt vmcnt(5)
  buffer_load_dwordx4 v[84:87], v2, s[32:35], s75 offen offset:1024 nt
  s_waitcnt vmcnt(5)
  buffer_load_dwordx4 v[88:91], v2, s[32:35], s75 offen offset:2048 nt
  s_waitcnt vmcnt(5)
  buffer_load_dwordx4 v[92:95], v2, s[32:35], s75 offen offset:3072 nt
  s_add_u32 s75, s75, 16384
  s_waitcnt vmcnt(5)
  buffer_load_dwordx4 v[96:99], v2, s[32:35], s75 offen offset:0 nt
  s_waitcnt vmcnt(5)
  buffer_load_dwordx4 v[100:103], v2, s[32:35], s75 offen offset:1024 nt
  s_waitcnt vmcnt(5)
  buffer_load_dwordx4 v[104:107], v2, s[32:35], s75 offen offset:2048 nt
  s_waitcnt vmcnt(5)
  buffer_load_dwordx4 v[108:111], v2, s[32:35], s75 offen offset:3072 nt
  s_add_u32 s75, s75, 16384
  s_waitcnt vmcnt(5)
  buffer_load_dwordx4 v[112:115], v2, s[32:35], s75 offen offset:0 nt
  s_waitcnt vmcnt(5)
  buffer_load_dwordx4 v[116:119], v2, s[32:35], s75 offen offset:1024 nt
  s_waitcnt vmcnt(5)
  buffer_load_dwordx4 v[120:123], v2, s[32:35], s75 offen offset:2048 nt
  s_waitcnt vmcnt(5)
  buffer_load_dwordx4 v[124:127], v2, s[32:35], s75 offen offset:3072 nt
  s_add_u32 s75, s75, 81920
  s_waitcnt vmcnt(5)
  buffer_load_dwordx4 v[128:131], v2, s[32:35], s75 offen offset:0 nt
  s_waitcnt vmcnt(5)
  buffer_load_dwordx4 v[132:135], v2, s[32:35], s75 offen offset:1024 nt
  s_waitcnt vmcnt(5)
  buffer_load_dwordx4 v[136:139], v2, s[32:35], s75 offen offset:2048 nt
  s_waitcnt vmcnt(5)
  buffer_load_dwordx4 v[140:143], v2, s[32:35], s75 offen offset:3072 nt
  s_add_u32 s75, s75, 16384
  s_waitcnt vmcnt(5)
  buffer_load_dwordx4 v[144:147], v2, s[32:35], s75 offen offset:0 nt
  s_waitcnt vmcnt(5)
  buffer_load_dwordx4 v[148:151], v2, s[32:35], s75 offen offset:1024 nt
  s_waitcnt vmcnt(5)
  buffer_load_dwordx4 v[152:155], v2, s[32:35], s75 offen offset:2048 nt
  s_waitcnt vmcnt(5)
  buffer_load_dwordx4 v[156:159], v2, s[32:35], s75 offen offset:3072 nt
  s_add_u32 s75, s75, 16384
  s_setprio 2
  s_add_u32 s36, s8, s77
  s_addc_u32 s37, s9, 0
  s_and_b32 s37, s37, 0xffff
  s_mov_b32 s38, 270532608
  s_mov_b32 s39, 0x00020000
  v_lshlrev_b32 v59, 9, v60
  v_lshl_add_u32 v59, v8, 7, v59
  v_lshl_add_u32 v59, v63, 5, v59
  s_mov_b32 s68, s28
  s_and_b32 s69, s29, 0xffff
  s_mov_b32 s70, 1646592
  s_mov_b32 s71, 0x00020000
  s_mov_b32 s80, 0x3db504f3
  s_mov_b32 s81, 0x3fb8aa3b
  s_mov_b32 s83, 0xbfb8aa3b
  s_mov_b32 s82, 0xffff0000
  v_and_b32 v63, 1, v1
  v_cmp_eq_u32 vcc, 1, v63
  v_mov_b32 v14, 0xffff
  v_mov_b32 v15, s82
  v_cndmask_b32 v14, v14, v15, vcc
  v_lshrrev_b32 v63, 1, v9
  v_cmp_eq_u32 vcc, 0, v63
  s_nop 1
  v_cndmask_b32 v4, 0, v14, vcc
  v_cmp_eq_u32 vcc, 1, v63
  s_nop 1
  v_cndmask_b32 v5, 0, v14, vcc
  v_cmp_eq_u32 vcc, 2, v63
  s_nop 1
  v_cndmask_b32 v6, 0, v14, vcc
  v_cmp_eq_u32 vcc, 3, v63
  s_nop 1
  v_cndmask_b32 v7, 0, v14, vcc
  v_lshlrev_b32 v61, 7, v8
  v_lshl_add_u32 v61, v9, 2, v61
  s_lshl_b32 s77, s91, 9
  s_add_u32 s77, s77, 36864
  v_add_u32 v61, s77, v61
  s_lshl_b32 s77, s91, 4
  v_mov_b32 v62, s77
  v_lshrrev_b32 v56, 2, v1
  v_lshlrev_b32 v56, 4, v56
  s_lshl_b32 s77, s91, 13
  v_add_u32 v56, s77, v56
  v_mov_b32 v57, v56
  v_mov_b32 v34, 0xff800000
  v_mov_b32 v33, 0
  v_mov_b32 v35, 0
  v_mov_b32 v28, 0
  v_mov_b32 v29, 0
  v_mov_b32 v30, 0
  v_mov_b32 v31, 0
  s_mov_b32 s48, s4
  s_and_b32 s49, s5, 0xffff
  s_mov_b32 s50, 8192
  s_mov_b32 s51, 0x00020000
  s_mov_b32 s64, s24
  s_and_b32 s65, s25, 0xffff
  s_mov_b32 s66, 8192
  s_mov_b32 s67, 0x00020000
  s_mov_b32 s43, 10866
  v_mov_b32 v63, 0
  ds_write_b32 v63, v63 offset:41920
  s_waitcnt lgkmcnt(0)
  s_mov_b32 s88, 0
  s_mov_b32 s45, 15
  s_waitcnt vmcnt(5)
  buffer_load_dwordx4 v[160:163], v2, s[32:35], s75 offen offset:0 nt
  s_waitcnt vmcnt(5)
  buffer_load_dwordx4 v[164:167], v2, s[32:35], s75 offen offset:1024 nt
  s_waitcnt vmcnt(5)
  buffer_load_dwordx4 v[168:171], v2, s[32:35], s75 offen offset:2048 nt
  s_waitcnt vmcnt(5)
  buffer_load_dwordx4 v[172:175], v2, s[32:35], s75 offen offset:3072 nt
  s_add_u32 s75, s75, 16384
  s_barrier
  ds_read_b128 v[40:43], v59 offset:32768
  ds_read_b128 v[44:47], v59 offset:32784
  s_waitcnt vmcnt(5)
  buffer_load_dwordx4 v[176:179], v2, s[32:35], s75 offen offset:0 nt
  s_waitcnt vmcnt(5)
  buffer_load_dwordx4 v[180:183], v2, s[32:35], s75 offen offset:1024 nt
  s_waitcnt vmcnt(5)
  buffer_load_dwordx4 v[184:187], v2, s[32:35], s75 offen offset:2048 nt
  s_waitcnt vmcnt(5)
  buffer_load_dwordx4 v[188:191], v2, s[32:35], s75 offen offset:3072 nt
  s_add_u32 s75, s75, 81920
  s_waitcnt lgkmcnt(0)
L_qbuild:
  v_add_f32_dpp v40, v40, v40 row_ror:4 row_mask:0xf bank_mask:0xf
  v_add_f32_dpp v41, v41, v41 row_ror:4 row_mask:0xf bank_mask:0xf
  v_add_f32_dpp v42, v42, v42 row_ror:4 row_mask:0xf bank_mask:0xf
  v_add_f32_dpp v43, v43, v43 row_ror:4 row_mask:0xf bank_mask:0xf
  v_add_f32_dpp v44, v44, v44 row_ror:4 row_mask:0xf bank_mask:0xf
  v_add_f32_dpp v45, v45, v45 row_ror:4 row_mask:0xf bank_mask:0xf
  v_add_f32_dpp v46, v46, v46 row_ror:4 row_mask:0xf bank_mask:0xf
  v_add_f32_dpp v47, v47, v47 row_ror:4 row_mask:0xf bank_mask:0xf
  v_add_f32_dpp v40, v40, v40 row_ror:8 row_mask:0xf bank_mask:0xf
  v_add_f32_dpp v41, v41, v41 row_ror:8 row_mask:0xf bank_mask:0xf
  v_add_f32_dpp v42, v42, v42 row_ror:8 row_mask:0xf bank_mask:0xf
  v_add_f32_dpp v43, v43, v43 row_ror:8 row_mask:0xf bank_mask:0xf
  v_add_f32_dpp v44, v44, v44 row_ror:8 row_mask:0xf bank_mask:0xf
  v_add_f32_dpp v45, v45, v45 row_ror:8 row_mask:0xf bank_mask:0xf
  v_add_f32_dpp v46, v46, v46 row_ror:8 row_mask:0xf bank_mask:0xf
  v_add_f32_dpp v47, v47, v47 row_ror:8 row_mask:0xf bank_mask:0xf
  v_cvt_pk_bf16_f32 v48, v40, v41
  v_cvt_pk_bf16_f32 v49, v42, v43
  v_cvt_pk_bf16_f32 v50, v44, v45
  v_cvt_pk_bf16_f32 v51, v46, v47
  v_cmp_eq_u32 vcc, 0, v60
  s_nop 1
  v_cndmask_b32 v8, 0, v48, vcc
  v_cndmask_b32 v9, 0, v49, vcc
  v_cndmask_b32 v10, 0, v50, vcc
  v_cndmask_b32 v11, 0, v51, vcc
  v_cmp_eq_u32 vcc, 1, v60
  s_nop 1
  v_cndmask_b32 v12, 0, v48, vcc
  v_cndmask_b32 v13, 0, v49, vcc
  v_cndmask_b32 v14, 0, v50, vcc
  v_cndmask_b32 v15, 0, v51, vcc
  v_cmp_eq_u32 vcc, 2, v60
  s_nop 1
  v_cndmask_b32 v16, 0, v48, vcc
  v_cndmask_b32 v17, 0, v49, vcc
  v_cndmask_b32 v18, 0, v50, vcc
  v_cndmask_b32 v19, 0, v51, vcc
  v_cmp_eq_u32 vcc, 3, v60
  s_nop 1
  v_cndmask_b32 v20, 0, v48, vcc
  v_cndmask_b32 v21, 0, v49, vcc
  v_cndmask_b32 v22, 0, v50, vcc
  v_cndmask_b32 v23, 0, v51, vcc
  s_cmp_lg_u32 s88, 0
  s_cbranch_scc1 L_k
  s_memrealtime s[40:41]
  s_waitcnt lgkmcnt(0)
  s_ashr_i32 s79, s43, 4
  s_sub_u32 s79, s79, s40
  s_add_u32 s43, s43, 3462
  s_add_u32 s42, s79, s94
  s_waitcnt vmcnt(44)
  v_mfma_f32_16x16x32_bf16 v[24:27], v[192:195], v[8:11], 0
  v_mfma_f32_16x16x32_bf16 v[24:27], v[196:199], v[12:15], v[24:27]
  v_mfma_f32_16x16x32_bf16 v[24:27], v[200:203], v[16:19], v[24:27]
  v_mfma_f32_16x16x32_bf16 v[24:27], v[204:207], v[20:23], v[24:27]
  s_waitcnt vmcnt(7)
  s_cmpk_lt_i32 s42, -450
  s_cbranch_scc1 L_go1978
  s_waitcnt vmcnt(6)
  s_cmpk_lt_i32 s42, -300
  s_cbranch_scc1 L_go1978
  s_waitcnt vmcnt(5)
  s_cmpk_lt_i32 s42, -150
  s_cbranch_scc1 L_go1978
  s_waitcnt vmcnt(4)
  s_cmpk_lt_i32 s42, 0
  s_cbranch_scc1 L_go1978
  s_waitcnt vmcnt(3)
L_go1978:
  buffer_load_dwordx4 v[192:195], v2, s[32:35], s75 offen offset:0 nt
  s_waitcnt vmcnt(7)
  s_cmpk_lt_i32 s42, -375
  s_cbranch_scc1 L_go1993
  s_waitcnt vmcnt(6)
  s_cmpk_lt_i32 s42, -225
  s_cbranch_scc1 L_go1993
  s_waitcnt vmcnt(5)
  s_cmpk_lt_i32 s42, -75
  s_cbranch_scc1 L_go1993
  s_waitcnt vmcnt(4)
  s_cmpk_lt_i32 s42, 75
  s_cbranch_scc1 L_go1993
  s_waitcnt vmcnt(3)
L_go1993:
  buffer_load_dwordx4 v[196:199], v2, s[32:35], s75 offen offset:1024 nt
  s_waitcnt vmcnt(7)
  s_cmpk_lt_i32 s42, -413
  s_cbranch_scc1 L_go2008
  s_waitcnt vmcnt(6)
  s_cmpk_lt_i32 s42, -263
  s_cbranch_scc1 L_go2008
  s_waitcnt vmcnt(5)
  s_cmpk_lt_i32 s42, -113
  s_cbranch_scc1 L_go2008
  s_waitcnt vmcnt(4)
  s_cmpk_lt_i32 s42, 37
  s_cbranch_scc1 L_go2008
  s_waitcnt vmcnt(3)
L_go2008:
  buffer_load_dwordx4 v[200:203], v2, s[32:35], s75 offen offset:2048 nt
  s_waitcnt vmcnt(7)
  s_cmpk_lt_i32 s42, -338
  s_cbranch_scc1 L_go2023
  s_waitcnt vmcnt(6)
  s_cmpk_lt_i32 s42, -188
  s_cbranch_scc1 L_go2023
  s_waitcnt vmcnt(5)
  s_cmpk_lt_i32 s42, -38
  s_cbranch_scc1 L_go2023
  s_waitcnt vmcnt(4)
  s_cmpk_lt_i32 s42, 112
  s_cbranch_scc1 L_go2023
  s_waitcnt vmcnt(3)
L_go2023:
  buffer_load_dwordx4 v[204:207], v2, s[32:35], s75 offen offset:3072 nt
  s_add_u32 s75, s75, 16384
  s_waitcnt vmcnt(32)
  v_mfma_f32_16x16x32_bf16 v[52:55], v[64:67], v[8:11], 0
  v_mfma_f32_16x16x32_bf16 v[52:55], v[68:71], v[12:15], v[52:55]
  v_mfma_f32_16x16x32_bf16 v[52:55], v[72:75], v[16:19], v[52:55]
  v_mfma_f32_16x16x32_bf16 v[52:55], v[76:79], v[20:23], v[52:55]
  v_mov_b32_dpp v58, v24 quad_perm:[0,0,0,0] row_mask:0xf bank_mask:0xf
  v_add_f32_dpp v58, v25, v58 quad_perm:[1,1,1,1] row_mask:0xf bank_mask:0xf
  v_add_f32_dpp v58, v26, v58 quad_perm:[2,2,2,2] row_mask:0xf bank_mask:0xf
  v_add_f32_dpp v58, v27, v58 quad_perm:[3,3,3,3] row_mask:0xf bank_mask:0xf
  v_cvt_pk_bf16_f32 v58, v58, v58
  v_and_b32 v58, s82, v58
  v_mul_f32 v58, s80, v58
  v_cvt_pk_bf16_f32 v58, v58, v58
  v_and_b32 v58, s82, v58
  ds_write_b32 v56, v58 offset:0
  v_max_f32 v34, v34, v58
  v_mov_b32_dpp v58, v52 quad_perm:[0,0,0,0] row_mask:0xf bank_mask:0xf
  v_add_f32_dpp v58, v53, v58 quad_perm:[1,1,1,1] row_mask:0xf bank_mask:0xf
  v_add_f32_dpp v58, v54, v58 quad_perm:[2,2,2,2] row_mask:0xf bank_mask:0xf
  v_add_f32_dpp v58, v55, v58 quad_perm:[3,3,3,3] row_mask:0xf bank_mask:0xf
  v_cvt_pk_bf16_f32 v58, v58, v58
  v_and_b32 v58, s82, v58
  v_mul_f32 v58, s80, v58
  v_cvt_pk_bf16_f32 v58, v58, v58
  v_and_b32 v58, s82, v58
  ds_write_b32 v57, v58 offset:256
  v_max_f32 v34, v34, v58
  s_waitcnt vmcnt(44)
  v_mfma_f32_16x16x32_bf16 v[24:27], v[208:211], v[8:11], 0
  v_mfma_f32_16x16x32_bf16 v[24:27], v[212:215], v[12:15], v[24:27]
  v_mfma_f32_16x16x32_bf16 v[24:27], v[216:219], v[16:19], v[24:27]
  v_mfma_f32_16x16x32_bf16 v[24:27], v[220:223], v[20:23], v[24:27]
  s_waitcnt vmcnt(7)
  s_cmpk_lt_i32 s42, -450
  s_cbranch_scc1 L_go2071
  s_waitcnt vmcnt(6)
  s_cmpk_lt_i32 s42, -300
  s_cbranch_scc1 L_go2071
  s_waitcnt vmcnt(5)
  s_cmpk_lt_i32 s42, -150
  s_cbranch_scc1 L_go2071
  s_waitcnt vmcnt(4)
  s_cmpk_lt_i32 s42, 0
  s_cbranch_scc1 L_go2071
  s_waitcnt vmcnt(3)
L_go2071:
  buffer_load_dwordx4 v[208:211], v2, s[32:35], s75 offen offset:0 nt
  s_waitcnt vmcnt(7)
  s_cmpk_lt_i32 s42, -375
  s_cbranch_scc1 L_go2086
  s_waitcnt vmcnt(6)
  s_cmpk_lt_i32 s42, -225
  s_cbranch_scc1 L_go2086
  s_waitcnt vmcnt(5)
  s_cmpk_lt_i32 s42, -75
  s_cbranch_scc1 L_go2086
  s_waitcnt vmcnt(4)
  s_cmpk_lt_i32 s42, 75
  s_cbranch_scc1 L_go2086
  s_waitcnt vmcnt(3)
L_go2086:
  buffer_load_dwordx4 v[212:215], v2, s[32:35], s75 offen offset:1024 nt
  s_waitcnt vmcnt(7)
  s_cmpk_lt_i32 s42, -413
  s_cbranch_scc1 L_go2101
  s_waitcnt vmcnt(6)
  s_cmpk_lt_i32 s42, -263
  s_cbranch_scc1 L_go2101
  s_waitcnt vmcnt(5)
  s_cmpk_lt_i32 s42, -113
  s_cbranch_scc1 L_go2101
  s_waitcnt vmcnt(4)
  s_cmpk_lt_i32 s42, 37
  s_cbranch_scc1 L_go2101
  s_waitcnt vmcnt(3)
L_go2101:
  buffer_load_dwordx4 v[216:219], v2, s[32:35], s75 offen offset:2048 nt
  s_waitcnt vmcnt(7)
  s_cmpk_lt_i32 s42, -338
  s_cbranch_scc1 L_go2116
  s_waitcnt vmcnt(6)
  s_cmpk_lt_i32 s42, -188
  s_cbranch_scc1 L_go2116
  s_waitcnt vmcnt(5)
  s_cmpk_lt_i32 s42, -38
  s_cbranch_scc1 L_go2116
  s_waitcnt vmcnt(4)
  s_cmpk_lt_i32 s42, 112
  s_cbranch_scc1 L_go2116
  s_waitcnt vmcnt(3)
L_go2116:
  buffer_load_dwordx4 v[220:223], v2, s[32:35], s75 offen offset:3072 nt
  s_add_u32 s75, s75, 16384
  s_waitcnt vmcnt(32)
  v_mfma_f32_16x16x32_bf16 v[52:55], v[80:83], v[8:11], 0
  v_mfma_f32_16x16x32_bf16 v[52:55], v[84:87], v[12:15], v[52:55]
  v_mfma_f32_16x16x32_bf16 v[52:55], v[88:91], v[16:19], v[52:55]
  v_mfma_f32_16x16x32_bf16 v[52:55], v[92:95], v[20:23], v[52:55]
  v_mov_b32_dpp v58, v24 quad_perm:[0,0,0,0] row_mask:0xf bank_mask:0xf
  v_add_f32_dpp v58, v25, v58 quad_perm:[1,1,1,1] row_mask:0xf bank_mask:0xf
  v_add_f32_dpp v58, v26, v58 quad_perm:[2,2,2,2] row_mask:0xf bank_mask:0xf
  v_add_f32_dpp v58, v27, v58 quad_perm:[3,3,3,3] row_mask:0xf bank_mask:0xf
  v_cvt_pk_bf16_f32 v58, v58, v58
  v_and_b32 v58, s82, v58
  v_mul_f32 v58, s80, v58
  v_cvt_pk_bf16_f32 v58, v58, v58
  v_and_b32 v58, s82, v58
  ds_write_b32 v56, v58 offset:4
  v_max_f32 v34, v34, v58
  v_mov_b32_dpp v58, v52 quad_perm:[0,0,0,0] row_mask:0xf bank_mask:0xf
  v_add_f32_dpp v58, v53, v58 quad_perm:[1,1,1,1] row_mask:0xf bank_mask:0xf
  v_add_f32_dpp v58, v54, v58 quad_perm:[2,2,2,2] row_mask:0xf bank_mask:0xf
  v_add_f32_dpp v58, v55, v58 quad_perm:[3,3,3,3] row_mask:0xf bank_mask:0xf
  v_cvt_pk_bf16_f32 v58, v58, v58
  v_and_b32 v58, s82, v58
  v_mul_f32 v58, s80, v58
  v_cvt_pk_bf16_f32 v58, v58, v58
  v_and_b32 v58, s82, v58
  ds_write_b32 v57, v58 offset:260
  v_max_f32 v34, v34, v58
  s_waitcnt vmcnt(44)
  v_mfma_f32_16x16x32_bf16 v[24:27], v[224:227], v[8:11], 0
  v_mfma_f32_16x16x32_bf16 v[24:27], v[228:231], v[12:15], v[24:27]
  v_mfma_f32_16x16x32_bf16 v[24:27], v[232:235], v[16:19], v[24:27]
  v_mfma_f32_16x16x32_bf16 v[24:27], v[236:239], v[20:23], v[24:27]
  s_waitcnt vmcnt(7)
  s_cmpk_lt_i32 s42, -450
  s_cbranch_scc1 L_go2164
  s_waitcnt vmcnt(6)
  s_cmpk_lt_i32 s42, -300
  s_cbranch_scc1 L_go2164
  s_waitcnt vmcnt(5)
  s_cmpk_lt_i32 s42, -150
  s_cbranch_scc1 L_go2164
  s_waitcnt vmcnt(4)
  s_cmpk_lt_i32 s42, 0
  s_cbranch_scc1 L_go2164
  s_waitcnt vmcnt(3)
L_go2164:
  buffer_load_dwordx4 v[224:227], v2, s[32:35], s75 offen offset:0 nt
  s_waitcnt vmcnt(7)
  s_cmpk_lt_i32 s42, -375
  s_cbranch_scc1 L_go2179
  s_waitcnt vmcnt(6)
  s_cmpk_lt_i32 s42, -225
  s_cbranch_scc1 L_go2179
  s_waitcnt vmcnt(5)
  s_cmpk_lt_i32 s42, -75
  s_cbranch_scc1 L_go2179
  s_waitcnt vmcnt(4)
  s_cmpk_lt_i32 s42, 75
  s_cbranch_scc1 L_go2179
  s_waitcnt vmcnt(3)
L_go2179:
  buffer_load_dwordx4 v[228:231], v2, s[32:35], s75 offen offset:1024 nt
  s_waitcnt vmcnt(7)
  s_cmpk_lt_i32 s42, -413
  s_cbranch_scc1 L_go2194
  s_waitcnt vmcnt(6)
  s_cmpk_lt_i32 s42, -263
  s_cbranch_scc1 L_go2194
  s_waitcnt vmcnt(5)
  s_cmpk_lt_i32 s42, -113
  s_cbranch_scc1 L_go2194
  s_waitcnt vmcnt(4)
  s_cmpk_lt_i32 s42, 37
  s_cbranch_scc1 L_go2194
  s_waitcnt vmcnt(3)
L_go2194:
  buffer_load_dwordx4 v[232:235], v2, s[32:35], s75 offen offset:2048 nt
  s_waitcnt vmcnt(7)
  s_cmpk_lt_i32 s42, -338
  s_cbranch_scc1 L_go2209
  s_waitcnt vmcnt(6)
  s_cmpk_lt_i32 s42, -188
  s_cbranch_scc1 L_go2209
  s_waitcnt vmcnt(5)
  s_cmpk_lt_i32 s42, -38
  s_cbranch_scc1 L_go2209
  s_waitcnt vmcnt(4)
  s_cmpk_lt_i32 s42, 112
  s_cbranch_scc1 L_go2209
  s_waitcnt vmcnt(3)
L_go2209:
  buffer_load_dwordx4 v[236:239], v2, s[32:35], s75 offen offset:3072 nt
  s_add_u32 s75, s75, 16384
  s_waitcnt vmcnt(32)
  v_mfma_f32_16x16x32_bf16 v[52:55], v[96:99], v[8:11], 0
  v_mfma_f32_16x16x32_bf16 v[52:55], v[100:103], v[12:15], v[52:55]
  v_mfma_f32_16x16x32_bf16 v[52:55], v[104:107], v[16:19], v[52:55]
  v_mfma_f32_16x16x32_bf16 v[52:55], v[108:111], v[20:23], v[52:55]
  v_mov_b32_dpp v58, v24 quad_perm:[0,0,0,0] row_mask:0xf bank_mask:0xf
  v_add_f32_dpp v58, v25, v58 quad_perm:[1,1,1,1] row_mask:0xf bank_mask:0xf
  v_add_f32_dpp v58, v26, v58 quad_perm:[2,2,2,2] row_mask:0xf bank_mask:0xf
  v_add_f32_dpp v58, v27, v58 quad_perm:[3,3,3,3] row_mask:0xf bank_mask:0xf
  v_cvt_pk_bf16_f32 v58, v58, v58
  v_and_b32 v58, s82, v58
  v_mul_f32 v58, s80, v58
  v_cvt_pk_bf16_f32 v58, v58, v58
  v_and_b32 v58, s82, v58
  ds_write_b32 v56, v58 offset:8
  v_max_f32 v34, v34, v58
  v_mov_b32_dpp v58, v52 quad_perm:[0,0,0,0] row_mask:0xf bank_mask:0xf
  v_add_f32_dpp v58, v53, v58 quad_perm:[1,1,1,1] row_mask:0xf bank_mask:0xf
  v_add_f32_dpp v58, v54, v58 quad_perm:[2,2,2,2] row_mask:0xf bank_mask:0xf
  v_add_f32_dpp v58, v55, v58 quad_perm:[3,3,3,3] row_mask:0xf bank_mask:0xf
  v_cvt_pk_bf16_f32 v58, v58, v58
  v_and_b32 v58, s82, v58
  v_mul_f32 v58, s80, v58
  v_cvt_pk_bf16_f32 v58, v58, v58
  v_and_b32 v58, s82, v58
  ds_write_b32 v57, v58 offset:264
  v_max_f32 v34, v34, v58
  s_waitcnt vmcnt(44)
  v_mfma_f32_16x16x32_bf16 v[24:27], v[240:243], v[8:11], 0
  v_mfma_f32_16x16x32_bf16 v[24:27], v[244:247], v[12:15], v[24:27]
  v_mfma_f32_16x16x32_bf16 v[24:27], v[248:251], v[16:19], v[24:27]
  v_mfma_f32_16x16x32_bf16 v[24:27], v[252:255], v[20:23], v[24:27]
  s_waitcnt vmcnt(7)
  s_cmpk_lt_i32 s42, -450
  s_cbranch_scc1 L_go2257
  s_waitcnt vmcnt(6)
  s_cmpk_lt_i32 s42, -300
  s_cbranch_scc1 L_go2257
  s_waitcnt vmcnt(5)
  s_cmpk_lt_i32 s42, -150
  s_cbranch_scc1 L_go2257
  s_waitcnt vmcnt(4)
  s_cmpk_lt_i32 s42, 0
  s_cbranch_scc1 L_go2257
  s_waitcnt vmcnt(3)
L_go2257:
  buffer_load_dwordx4 v[240:243], v2, s[32:35], s75 offen offset:0 nt
  s_waitcnt vmcnt(7)
  s_cmpk_lt_i32 s42, -375
  s_cbranch_scc1 L_go2272
  s_waitcnt vmcnt(6)
  s_cmpk_lt_i32 s42, -225
  s_cbranch_scc1 L_go2272
  s_waitcnt vmcnt(5)
  s_cmpk_lt_i32 s42, -75
  s_cbranch_scc1 L_go2272
  s_waitcnt vmcnt(4)
  s_cmpk_lt_i32 s42, 75
  s_cbranch_scc1 L_go2272
  s_waitcnt vmcnt(3)
L_go2272:
  buffer_load_dwordx4 v[244:247], v2, s[32:35], s75 offen offset:1024 nt
  s_waitcnt vmcnt(7)
  s_cmpk_lt_i32 s42, -413
  s_cbranch_scc1 L_go2287
  s_waitcnt vmcnt(6)
  s_cmpk_lt_i32 s42, -263
  s_cbranch_scc1 L_go2287
  s_waitcnt vmcnt(5)
  s_cmpk_lt_i32 s42, -113
  s_cbranch_scc1 L_go2287
  s_waitcnt vmcnt(4)
  s_cmpk_lt_i32 s42, 37
  s_cbranch_scc1 L_go2287
  s_waitcnt vmcnt(3)
L_go2287:
  buffer_load_dwordx4 v[248:251], v2, s[32:35], s75 offen offset:2048 nt
  s_waitcnt vmcnt(7)
  s_cmpk_lt_i32 s42, -338
  s_cbranch_scc1 L_go2302
  s_waitcnt vmcnt(6)
  s_cmpk_lt_i32 s42, -188
  s_cbranch_scc1 L_go2302
  s_waitcnt vmcnt(5)
  s_cmpk_lt_i32 s42, -38
  s_cbranch_scc1 L_go2302
  s_waitcnt vmcnt(4)
  s_cmpk_lt_i32 s42, 112
  s_cbranch_scc1 L_go2302
  s_waitcnt vmcnt(3)
L_go2302:
  s_memrealtime s[40:41]
  buffer_load_dwordx4 v[252:255], v2, s[32:35], s75 offen offset:3072 nt
  s_add_u32 s75, s75, 81920
  s_waitcnt vmcnt(32)
  v_mfma_f32_16x16x32_bf16 v[52:55], v[112:115], v[8:11], 0
  v_mfma_f32_16x16x32_bf16 v[52:55], v[116:119], v[12:15], v[52:55]
  v_mfma_f32_16x16x32_bf16 v[52:55], v[120:123], v[16:19], v[52:55]
  v_mfma_f32_16x16x32_bf16 v[52:55], v[124:127], v[20:23], v[52:55]
  v_mov_b32_dpp v58, v24 quad_perm:[0,0,0,0] row_mask:0xf bank_mask:0xf
  v_add_f32_dpp v58, v25, v58 quad_perm:[1,1,1,1] row_mask:0xf bank_mask:0xf
  v_add_f32_dpp v58, v26, v58 quad_perm:[2,2,2,2] row_mask:0xf bank_mask:0xf
  v_add_f32_dpp v58, v27, v58 quad_perm:[3,3,3,3] row_mask:0xf bank_mask:0xf
  v_cvt_pk_bf16_f32 v58, v58, v58
  v_and_b32 v58, s82, v58
  v_mul_f32 v58, s80, v58
  v_cvt_pk_bf16_f32 v58, v58, v58
  v_and_b32 v58, s82, v58
  ds_write_b32 v56, v58 offset:12
  v_max_f32 v34, v34, v58
  v_mov_b32_dpp v58, v52 quad_perm:[0,0,0,0] row_mask:0xf bank_mask:0xf
  v_add_f32_dpp v58, v53, v58 quad_perm:[1,1,1,1] row_mask:0xf bank_mask:0xf
  v_add_f32_dpp v58, v54, v58 quad_perm:[2,2,2,2] row_mask:0xf bank_mask:0xf
  v_add_f32_dpp v58, v55, v58 quad_perm:[3,3,3,3] row_mask:0xf bank_mask:0xf
  v_cvt_pk_bf16_f32 v58, v58, v58
  v_and_b32 v58, s82, v58
  v_mul_f32 v58, s80, v58
  v_cvt_pk_bf16_f32 v58, v58, v58
  v_and_b32 v58, s82, v58
  ds_write_b32 v57, v58 offset:268
  v_max_f32 v34, v34, v58
  v_add_u32 v56, 768, v56
  s_waitcnt lgkmcnt(0)
  s_ashr_i32 s79, s43, 4
  s_sub_u32 s79, s79, s40
  s_add_u32 s43, s43, 3462
  s_add_u32 s42, s79, s94
  s_waitcnt vmcnt(12)
  v_mfma_f32_16x16x32_bf16 v[24:27], v[192:195], v[8:11], 0
  v_mfma_f32_16x16x32_bf16 v[24:27], v[196:199], v[12:15], v[24:27]
  v_mfma_f32_16x16x32_bf16 v[24:27], v[200:203], v[16:19], v[24:27]
  v_mfma_f32_16x16x32_bf16 v[24:27], v[204:207], v[20:23], v[24:27]
  s_waitcnt vmcnt(7)
  s_cmpk_lt_i32 s42, -450
  s_cbranch_scc1 L_go2357
  s_waitcnt vmcnt(6)
  s_cmpk_lt_i32 s42, -300
  s_cbranch_scc1 L_go2357
  s_waitcnt vmcnt(5)
  s_cmpk_lt_i32 s42, -150
  s_cbranch_scc1 L_go2357
  s_waitcnt vmcnt(4)
  s_cmpk_lt_i32 s42, 0
  s_cbranch_scc1 L_go2357
  s_waitcnt vmcnt(3)
L_go2357:
  buffer_load_dwordx4 v[192:195], v2, s[32:35], s75 offen offset:0 nt
  s_waitcnt vmcnt(7)
  s_cmpk_lt_i32 s42, -375
  s_cbranch_scc1 L_go2372
  s_waitcnt vmcnt(6)
  s_cmpk_lt_i32 s42, -225
  s_cbranch_scc1 L_go2372
  s_waitcnt vmcnt(5)
  s_cmpk_lt_i32 s42, -75
  s_cbranch_scc1 L_go2372
  s_waitcnt vmcnt(4)
  s_cmpk_lt_i32 s42, 75
  s_cbranch_scc1 L_go2372
  s_waitcnt vmcnt(3)
L_go2372:
  buffer_load_dwordx4 v[196:199], v2, s[32:35], s75 offen offset:1024 nt
  s_waitcnt vmcnt(7)
  s_cmpk_lt_i32 s42, -413
  s_cbranch_scc1 L_go2387
  s_waitcnt vmcnt(6)
  s_cmpk_lt_i32 s42, -263
  s_cbranch_scc1 L_go2387
  s_waitcnt vmcnt(5)
  s_cmpk_lt_i32 s42, -113
  s_cbranch_scc1 L_go2387
  s_waitcnt vmcnt(4)
  s_cmpk_lt_i32 s42, 37
  s_cbranch_scc1 L_go2387
  s_waitcnt vmcnt(3)
L_go2387:
  buffer_load_dwordx4 v[200:203], v2, s[32:35], s75 offen offset:2048 nt
  s_waitcnt vmcnt(7)
  s_cmpk_lt_i32 s42, -338
  s_cbranch_scc1 L_go2402
  s_waitcnt vmcnt(6)
  s_cmpk_lt_i32 s42, -188
  s_cbranch_scc1 L_go2402
  s_waitcnt vmcnt(5)
  s_cmpk_lt_i32 s42, -38
  s_cbranch_scc1 L_go2402
  s_waitcnt vmcnt(4)
  s_cmpk_lt_i32 s42, 112
  s_cbranch_scc1 L_go2402
  s_waitcnt vmcnt(3)
L_go2402:
  buffer_load_dwordx4 v[204:207], v2, s[32:35], s75 offen offset:3072 nt
  s_add_u32 s75, s75, 16384
  s_waitcnt vmcnt(32)
  v_mfma_f32_16x16x32_bf16 v[52:55], v[128:131], v[8:11], 0
  v_mfma_f32_16x16x32_bf16 v[52:55], v[132:135], v[12:15], v[52:55]
  v_mfma_f32_16x16x32_bf16 v[52:55], v[136:139], v[16:19], v[52:55]
  v_mfma_f32_16x16x32_bf16 v[52:55], v[140:143], v[20:23], v[52:55]
  v_mov_b32_dpp v58, v24 quad_perm:[0,0,0,0] row_mask:0xf bank_mask:0xf
  v_add_f32_dpp v58, v25, v58 quad_perm:[1,1,1,1] row_mask:0xf bank_mask:0xf
  v_add_f32_dpp v58, v26, v58 quad_perm:[2,2,2,2] row_mask:0xf bank_mask:0xf
  v_add_f32_dpp v58, v27, v58 quad_perm:[3,3,3,3] row_mask:0xf bank_mask:0xf
  v_cvt_pk_bf16_f32 v58, v58, v58
  v_and_b32 v58, s82, v58
  v_mul_f32 v58, s80, v58
  v_cvt_pk_bf16_f32 v58, v58, v58
  v_and_b32 v58, s82, v58
  ds_write_b32 v56, v58 offset:0
  v_max_f32 v34, v34, v58
  v_mov_b32_dpp v58, v52 quad_perm:[0,0,0,0] row_mask:0xf bank_mask:0xf
  v_add_f32_dpp v58, v53, v58 quad_perm:[1,1,1,1] row_mask:0xf bank_mask:0xf
  v_add_f32_dpp v58, v54, v58 quad_perm:[2,2,2,2] row_mask:0xf bank_mask:0xf
  v_add_f32_dpp v58, v55, v58 quad_perm:[3,3,3,3] row_mask:0xf bank_mask:0xf
  v_cvt_pk_bf16_f32 v58, v58, v58
  v_and_b32 v58, s82, v58
  v_mul_f32 v58, s80, v58
  v_cvt_pk_bf16_f32 v58, v58, v58
  v_and_b32 v58, s82, v58
  ds_write_b32 v57, v58 offset:512
  v_max_f32 v34, v34, v58
  s_waitcnt vmcnt(12)
  v_mfma_f32_16x16x32_bf16 v[24:27], v[208:211], v[8:11], 0
  v_mfma_f32_16x16x32_bf16 v[24:27], v[212:215], v[12:15], v[24:27]
  v_mfma_f32_16x16x32_bf16 v[24:27], v[216:219], v[16:19], v[24:27]
  v_mfma_f32_16x16x32_bf16 v[24:27], v[220:223], v[20:23], v[24:27]
  s_waitcnt vmcnt(7)
  s_cmpk_lt_i32 s42, -450
  s_cbranch_scc1 L_go2450
  s_waitcnt vmcnt(6)
  s_cmpk_lt_i32 s42, -300
  s_cbranch_scc1 L_go2450
  s_waitcnt vmcnt(5)
  s_cmpk_lt_i32 s42, -150
  s_cbranch_scc1 L_go2450
  s_waitcnt vmcnt(4)
  s_cmpk_lt_i32 s42, 0
  s_cbranch_scc1 L_go2450
  s_waitcnt vmcnt(3)
L_go2450:
  buffer_load_dwordx4 v[208:211], v2, s[32:35], s75 offen offset:0 nt
  s_waitcnt vmcnt(7)
  s_cmpk_lt_i32 s42, -375
  s_cbranch_scc1 L_go2465
  s_waitcnt vmcnt(6)
  s_cmpk_lt_i32 s42, -225
  s_cbranch_scc1 L_go2465
  s_waitcnt vmcnt(5)
  s_cmpk_lt_i32 s42, -75
  s_cbranch_scc1 L_go2465
  s_waitcnt vmcnt(4)
  s_cmpk_lt_i32 s42, 75
  s_cbranch_scc1 L_go2465
  s_waitcnt vmcnt(3)
L_go2465:
  buffer_load_dwordx4 v[212:215], v2, s[32:35], s75 offen offset:1024 nt
  s_waitcnt vmcnt(7)
  s_cmpk_lt_i32 s42, -413
  s_cbranch_scc1 L_go2480
  s_waitcnt vmcnt(6)
  s_cmpk_lt_i32 s42, -263
  s_cbranch_scc1 L_go2480
  s_waitcnt vmcnt(5)
  s_cmpk_lt_i32 s42, -113
  s_cbranch_scc1 L_go2480
  s_waitcnt vmcnt(4)
  s_cmpk_lt_i32 s42, 37
  s_cbranch_scc1 L_go2480
  s_waitcnt vmcnt(3)
L_go2480:
  buffer_load_dwordx4 v[216:219], v2, s[32:35], s75 offen offset:2048 nt
  s_waitcnt vmcnt(7)
  s_cmpk_lt_i32 s42, -338
  s_cbranch_scc1 L_go2495
  s_waitcnt vmcnt(6)
  s_cmpk_lt_i32 s42, -188
  s_cbranch_scc1 L_go2495
  s_waitcnt vmcnt(5)
  s_cmpk_lt_i32 s42, -38
  s_cbranch_scc1 L_go2495
  s_waitcnt vmcnt(4)
  s_cmpk_lt_i32 s42, 112
  s_cbranch_scc1 L_go2495
  s_waitcnt vmcnt(3)
L_go2495:
  buffer_load_dwordx4 v[220:223], v2, s[32:35], s75 offen offset:3072 nt
  s_add_u32 s75, s75, 16384
  s_waitcnt vmcnt(32)
  v_mfma_f32_16x16x32_bf16 v[52:55], v[144:147], v[8:11], 0
  v_mfma_f32_16x16x32_bf16 v[52:55], v[148:151], v[12:15], v[52:55]
  v_mfma_f32_16x16x32_bf16 v[52:55], v[152:155], v[16:19], v[52:55]
  v_mfma_f32_16x16x32_bf16 v[52:55], v[156:159], v[20:23], v[52:55]
  v_mov_b32_dpp v58, v24 quad_perm:[0,0,0,0] row_mask:0xf bank_mask:0xf
  v_add_f32_dpp v58, v25, v58 quad_perm:[1,1,1,1] row_mask:0xf bank_mask:0xf
  v_add_f32_dpp v58, v26, v58 quad_perm:[2,2,2,2] row_mask:0xf bank_mask:0xf
  v_add_f32_dpp v58, v27, v58 quad_perm:[3,3,3,3] row_mask:0xf bank_mask:0xf
  v_cvt_pk_bf16_f32 v58, v58, v58
  v_and_b32 v58, s82, v58
  v_mul_f32 v58, s80, v58
  v_cvt_pk_bf16_f32 v58, v58, v58
  v_and_b32 v58, s82, v58
  ds_write_b32 v56, v58 offset:4
  v_max_f32 v34, v34, v58
  v_mov_b32_dpp v58, v52 quad_perm:[0,0,0,0] row_mask:0xf bank_mask:0xf
  v_add_f32_dpp v58, v53, v58 quad_perm:[1,1,1,1] row_mask:0xf bank_mask:0xf
  v_add_f32_dpp v58, v54, v58 quad_perm:[2,2,2,2] row_mask:0xf bank_mask:0xf
  v_add_f32_dpp v58, v55, v58 quad_perm:[3,3,3,3] row_mask:0xf bank_mask:0xf
  v_cvt_pk_bf16_f32 v58, v58, v58
  v_and_b32 v58, s82, v58
  v_mul_f32 v58, s80, v58
  v_cvt_pk_bf16_f32 v58, v58, v58
  v_and_b32 v58, s82, v58
  ds_write_b32 v57, v58 offset:516
  v_max_f32 v34, v34, v58
  s_waitcnt vmcnt(12)
  v_mfma_f32_16x16x32_bf16 v[24:27], v[224:227], v[8:11], 0
  v_mfma_f32_16x16x32_bf16 v[24:27], v[228:231], v[12:15], v[24:27]
  v_mfma_f32_16x16x32_bf16 v[24:27], v[232:235], v[16:19], v[24:27]
  v_mfma_f32_16x16x32_bf16 v[24:27], v[236:239], v[20:23], v[24:27]
  s_waitcnt vmcnt(7)
  s_cmpk_lt_i32 s42, -450
  s_cbranch_scc1 L_go2543
  s_waitcnt vmcnt(6)
  s_cmpk_lt_i32 s42, -300
  s_cbranch_scc1 L_go2543
  s_waitcnt vmcnt(5)
  s_cmpk_lt_i32 s42, -150
  s_cbranch_scc1 L_go2543
  s_waitcnt vmcnt(4)
  s_cmpk_lt_i32 s42, 0
  s_cbranch_scc1 L_go2543
  s_waitcnt vmcnt(3)
L_go2543:
  buffer_load_dwordx4 v[224:227], v2, s[32:35], s75 offen offset:0 nt
  s_waitcnt vmcnt(7)
  s_cmpk_lt_i32 s42, -375
  s_cbranch_scc1 L_go2558
  s_waitcnt vmcnt(6)
  s_cmpk_lt_i32 s42, -225
  s_cbranch_scc1 L_go2558
  s_waitcnt vmcnt(5)
  s_cmpk_lt_i32 s42, -75
  s_cbranch_scc1 L_go2558
  s_waitcnt vmcnt(4)
  s_cmpk_lt_i32 s42, 75
  s_cbranch_scc1 L_go2558
  s_waitcnt vmcnt(3)
L_go2558:
  buffer_load_dwordx4 v[228:231], v2, s[32:35], s75 offen offset:1024 nt
  s_waitcnt vmcnt(7)
  s_cmpk_lt_i32 s42, -413
  s_cbranch_scc1 L_go2573
  s_waitcnt vmcnt(6)
  s_cmpk_lt_i32 s42, -263
  s_cbranch_scc1 L_go2573
  s_waitcnt vmcnt(5)
  s_cmpk_lt_i32 s42, -113
  s_cbranch_scc1 L_go2573
  s_waitcnt vmcnt(4)
  s_cmpk_lt_i32 s42, 37
  s_cbranch_scc1 L_go2573
  s_waitcnt vmcnt(3)
L_go2573:
  buffer_load_dwordx4 v[232:235], v2, s[32:35], s75 offen offset:2048 nt
  s_waitcnt vmcnt(7)
  s_cmpk_lt_i32 s42, -338
  s_cbranch_scc1 L_go2588
  s_waitcnt vmcnt(6)
  s_cmpk_lt_i32 s42, -188
  s_cbranch_scc1 L_go2588
  s_waitcnt vmcnt(5)
  s_cmpk_lt_i32 s42, -38
  s_cbranch_scc1 L_go2588
  s_waitcnt vmcnt(4)
  s_cmpk_lt_i32 s42, 112
  s_cbranch_scc1 L_go2588
  s_waitcnt vmcnt(3)
L_go2588:
  buffer_load_dwordx4 v[236:239], v2, s[32:35], s75 offen offset:3072 nt
  s_add_u32 s75, s75, 16384
  s_waitcnt vmcnt(32)
  v_mfma_f32_16x16x32_bf16 v[52:55], v[160:163], v[8:11], 0
  v_mfma_f32_16x16x32_bf16 v[52:55], v[164:167], v[12:15], v[52:55]
  v_mfma_f32_16x16x32_bf16 v[52:55], v[168:171], v[16:19], v[52:55]
  v_mfma_f32_16x16x32_bf16 v[52:55], v[172:175], v[20:23], v[52:55]
  v_mov_b32_dpp v58, v24 quad_perm:[0,0,0,0] row_mask:0xf bank_mask:0xf
  v_add_f32_dpp v58, v25, v58 quad_perm:[1,1,1,1] row_mask:0xf bank_mask:0xf
  v_add_f32_dpp v58, v26, v58 quad_perm:[2,2,2,2] row_mask:0xf bank_mask:0xf
  v_add_f32_dpp v58, v27, v58 quad_perm:[3,3,3,3] row_mask:0xf bank_mask:0xf
  v_cvt_pk_bf16_f32 v58, v58, v58
  v_and_b32 v58, s82, v58
  v_mul_f32 v58, s80, v58
  v_cvt_pk_bf16_f32 v58, v58, v58
  v_and_b32 v58, s82, v58
  ds_write_b32 v56, v58 offset:8
  v_max_f32 v34, v34, v58
  v_mov_b32_dpp v58, v52 quad_perm:[0,0,0,0] row_mask:0xf bank_mask:0xf
  v_add_f32_dpp v58, v53, v58 quad_perm:[1,1,1,1] row_mask:0xf bank_mask:0xf
  v_add_f32_dpp v58, v54, v58 quad_perm:[2,2,2,2] row_mask:0xf bank_mask:0xf
  v_add_f32_dpp v58, v55, v58 quad_perm:[3,3,3,3] row_mask:0xf bank_mask:0xf
  v_cvt_pk_bf16_f32 v58, v58, v58
  v_and_b32 v58, s82, v58
  v_mul_f32 v58, s80, v58
  v_cvt_pk_bf16_f32 v58, v58, v58
  v_and_b32 v58, s82, v58
  ds_write_b32 v57, v58 offset:520
  v_max_f32 v34, v34, v58
  s_waitcnt vmcnt(12)
  v_mfma_f32_16x16x32_bf16 v[24:27], v[240:243], v[8:11], 0
  v_mfma_f32_16x16x32_bf16 v[24:27], v[244:247], v[12:15], v[24:27]
  v_mfma_f32_16x16x32_bf16 v[24:27], v[248:251], v[16:19], v[24:27]
  v_mfma_f32_16x16x32_bf16 v[24:27], v[252:255], v[20:23], v[24:27]
  s_waitcnt vmcnt(7)
  s_cmpk_lt_i32 s42, -450
  s_cbranch_scc1 L_go2636
  s_waitcnt vmcnt(6)
  s_cmpk_lt_i32 s42, -300
  s_cbranch_scc1 L_go2636
  s_waitcnt vmcnt(5)
  s_cmpk_lt_i32 s42, -150
  s_cbranch_scc1 L_go2636
  s_waitcnt vmcnt(4)
  s_cmpk_lt_i32 s42, 0
  s_cbranch_scc1 L_go2636
  s_waitcnt vmcnt(3)
L_go2636:
  buffer_load_dwordx4 v[240:243], v2, s[32:35], s75 offen offset:0 nt
  s_waitcnt vmcnt(7)
  s_cmpk_lt_i32 s42, -375
  s_cbranch_scc1 L_go2651
  s_waitcnt vmcnt(6)
  s_cmpk_lt_i32 s42, -225
  s_cbranch_scc1 L_go2651
  s_waitcnt vmcnt(5)
  s_cmpk_lt_i32 s42, -75
  s_cbranch_scc1 L_go2651
  s_waitcnt vmcnt(4)
  s_cmpk_lt_i32 s42, 75
  s_cbranch_scc1 L_go2651
  s_waitcnt vmcnt(3)
L_go2651:
  buffer_load_dwordx4 v[244:247], v2, s[32:35], s75 offen offset:1024 nt
  s_waitcnt vmcnt(7)
  s_cmpk_lt_i32 s42, -413
  s_cbranch_scc1 L_go2666
  s_waitcnt vmcnt(6)
  s_cmpk_lt_i32 s42, -263
  s_cbranch_scc1 L_go2666
  s_waitcnt vmcnt(5)
  s_cmpk_lt_i32 s42, -113
  s_cbranch_scc1 L_go2666
  s_waitcnt vmcnt(4)
  s_cmpk_lt_i32 s42, 37
  s_cbranch_scc1 L_go2666
  s_waitcnt vmcnt(3)
L_go2666:
  buffer_load_dwordx4 v[248:251], v2, s[32:35], s75 offen offset:2048 nt
  s_waitcnt vmcnt(7)
  s_cmpk_lt_i32 s42, -338
  s_cbranch_scc1 L_go2681
  s_waitcnt vmcnt(6)
  s_cmpk_lt_i32 s42, -188
  s_cbranch_scc1 L_go2681
  s_waitcnt vmcnt(5)
  s_cmpk_lt_i32 s42, -38
  s_cbranch_scc1 L_go2681
  s_waitcnt vmcnt(4)
  s_cmpk_lt_i32 s42, 112
  s_cbranch_scc1 L_go2681
  s_waitcnt vmcnt(3)
L_go2681:
  s_memrealtime s[40:41]
  buffer_load_dwordx4 v[252:255], v2, s[32:35], s75 offen offset:3072 nt
  s_add_u32 s75, s75, 81920
  s_waitcnt vmcnt(32)
  v_mfma_f32_16x16x32_bf16 v[52:55], v[176:179], v[8:11], 0
  v_mfma_f32_16x16x32_bf16 v[52:55], v[180:183], v[12:15], v[52:55]
  v_mfma_f32_16x16x32_bf16 v[52:55], v[184:187], v[16:19], v[52:55]
  v_mfma_f32_16x16x32_bf16 v[52:55], v[188:191], v[20:23], v[52:55]
  v_mov_b32_dpp v58, v24 quad_perm:[0,0,0,0] row_mask:0xf bank_mask:0xf
  v_add_f32_dpp v58, v25, v58 quad_perm:[1,1,1,1] row_mask:0xf bank_mask:0xf
  v_add_f32_dpp v58, v26, v58 quad_perm:[2,2,2,2] row_mask:0xf bank_mask:0xf
  v_add_f32_dpp v58, v27, v58 quad_perm:[3,3,3,3] row_mask:0xf bank_mask:0xf
  v_cvt_pk_bf16_f32 v58, v58, v58
  v_and_b32 v58, s82, v58
  v_mul_f32 v58, s80, v58
  v_cvt_pk_bf16_f32 v58, v58, v58
  v_and_b32 v58, s82, v58
  ds_write_b32 v56, v58 offset:12
  v_max_f32 v34, v34, v58
  v_mov_b32_dpp v58, v52 quad_perm:[0,0,0,0] row_mask:0xf bank_mask:0xf
  v_add_f32_dpp v58, v53, v58 quad_perm:[1,1,1,1] row_mask:0xf bank_mask:0xf
  v_add_f32_dpp v58, v54, v58 quad_perm:[2,2,2,2] row_mask:0xf bank_mask:0xf
  v_add_f32_dpp v58, v55, v58 quad_perm:[3,3,3,3] row_mask:0xf bank_mask:0xf
  v_cvt_pk_bf16_f32 v58, v58, v58
  v_and_b32 v58, s82, v58
  v_mul_f32 v58, s80, v58
  v_cvt_pk_bf16_f32 v58, v58, v58
  v_and_b32 v58, s82, v58
  ds_write_b32 v57, v58 offset:524
  v_max_f32 v34, v34, v58
  v_add_u32 v56, 256, v56
  s_mov_b32 s88, 4
L_k:
  s_waitcnt lgkmcnt(0)
  s_ashr_i32 s79, s43, 4
  s_sub_u32 s79, s79, s40
  s_add_u32 s43, s43, 3462
  s_add_u32 s42, s79, s94
  s_waitcnt vmcnt(12)
  v_mfma_f32_16x16x32_bf16 v[24:27], v[192:195], v[8:11], 0
  v_mfma_f32_16x16x32_bf16 v[24:27], v[196:199], v[12:15], v[24:27]
  v_mfma_f32_16x16x32_bf16 v[24:27], v[200:203], v[16:19], v[24:27]
  v_mfma_f32_16x16x32_bf16 v[24:27], v[204:207], v[20:23], v[24:27]
  s_waitcnt vmcnt(7)
  s_cmpk_lt_i32 s42, -450
  s_cbranch_scc1 L_go2738
  s_waitcnt vmcnt(6)
  s_cmpk_lt_i32 s42, -300
  s_cbranch_scc1 L_go2738
  s_waitcnt vmcnt(5)
  s_cmpk_lt_i32 s42, -150
  s_cbranch_scc1 L_go2738
  s_waitcnt vmcnt(4)
  s_cmpk_lt_i32 s42, 0
  s_cbranch_scc1 L_go2738
  s_waitcnt vmcnt(3)
L_go2738:
  buffer_load_dwordx4 v[192:195], v2, s[32:35], s75 offen offset:0 nt
  s_waitcnt vmcnt(7)
  s_cmpk_lt_i32 s42, -375
  s_cbranch_scc1 L_go2753
  s_waitcnt vmcnt(6)
  s_cmpk_lt_i32 s42, -225
  s_cbranch_scc1 L_go2753
  s_waitcnt vmcnt(5)
  s_cmpk_lt_i32 s42, -75
  s_cbranch_scc1 L_go2753
  s_waitcnt vmcnt(4)
  s_cmpk_lt_i32 s42, 75
  s_cbranch_scc1 L_go2753
  s_waitcnt vmcnt(3)
L_go2753:
  buffer_load_dwordx4 v[196:199], v2, s[32:35], s75 offen offset:1024 nt
  s_waitcnt vmcnt(7)
  s_cmpk_lt_i32 s42, -413
  s_cbranch_scc1 L_go2768
  s_waitcnt vmcnt(6)
  s_cmpk_lt_i32 s42, -263
  s_cbranch_scc1 L_go2768
  s_waitcnt vmcnt(5)
  s_cmpk_lt_i32 s42, -113
  s_cbranch_scc1 L_go2768
  s_waitcnt vmcnt(4)
  s_cmpk_lt_i32 s42, 37
  s_cbranch_scc1 L_go2768
  s_waitcnt vmcnt(3)
L_go2768:
  buffer_load_dwordx4 v[200:203], v2, s[32:35], s75 offen offset:2048 nt
  s_waitcnt vmcnt(7)
  s_cmpk_lt_i32 s42, -338
  s_cbranch_scc1 L_go2783
  s_waitcnt vmcnt(6)
  s_cmpk_lt_i32 s42, -188
  s_cbranch_scc1 L_go2783
  s_waitcnt vmcnt(5)
  s_cmpk_lt_i32 s42, -38
  s_cbranch_scc1 L_go2783
  s_waitcnt vmcnt(4)
  s_cmpk_lt_i32 s42, 112
  s_cbranch_scc1 L_go2783
  s_waitcnt vmcnt(3)
L_go2783:
  buffer_load_dwordx4 v[204:207], v2, s[32:35], s75 offen offset:3072 nt
  s_add_u32 s75, s75, 16384
  v_mov_b32_dpp v58, v24 quad_perm:[0,0,0,0] row_mask:0xf bank_mask:0xf
  v_add_f32_dpp v58, v25, v58 quad_perm:[1,1,1,1] row_mask:0xf bank_mask:0xf
  v_add_f32_dpp v58, v26, v58 quad_perm:[2,2,2,2] row_mask:0xf bank_mask:0xf
  v_add_f32_dpp v58, v27, v58 quad_perm:[3,3,3,3] row_mask:0xf bank_mask:0xf
  v_cvt_pk_bf16_f32 v58, v58, v58
  v_and_b32 v58, s82, v58
  v_mul_f32 v58, s80, v58
  v_cvt_pk_bf16_f32 v58, v58, v58
  v_and_b32 v58, s82, v58
  ds_write_b32 v56, v58 offset:0
  v_max_f32 v34, v34, v58
  s_waitcnt vmcnt(12)
  v_mfma_f32_16x16x32_bf16 v[24:27], v[208:211], v[8:11], 0
  v_mfma_f32_16x16x32_bf16 v[24:27], v[212:215], v[12:15], v[24:27]
  v_mfma_f32_16x16x32_bf16 v[24:27], v[216:219], v[16:19], v[24:27]
  v_mfma_f32_16x16x32_bf16 v[24:27], v[220:223], v[20:23], v[24:27]
  s_waitcnt vmcnt(7)
  s_cmpk_lt_i32 s42, -450
  s_cbranch_scc1 L_go2815
  s_waitcnt vmcnt(6)
  s_cmpk_lt_i32 s42, -300
  s_cbranch_scc1 L_go2815
  s_waitcnt vmcnt(5)
  s_cmpk_lt_i32 s42, -150
  s_cbranch_scc1 L_go2815
  s_waitcnt vmcnt(4)
  s_cmpk_lt_i32 s42, 0
  s_cbranch_scc1 L_go2815
  s_waitcnt vmcnt(3)
L_go2815:
  buffer_load_dwordx4 v[208:211], v2, s[32:35], s75 offen offset:0 nt
  s_waitcnt vmcnt(7)
  s_cmpk_lt_i32 s42, -375
  s_cbranch_scc1 L_go2830
  s_waitcnt vmcnt(6)
  s_cmpk_lt_i32 s42, -225
  s_cbranch_scc1 L_go2830
  s_waitcnt vmcnt(5)
  s_cmpk_lt_i32 s42, -75
  s_cbranch_scc1 L_go2830
  s_waitcnt vmcnt(4)
  s_cmpk_lt_i32 s42, 75
  s_cbranch_scc1 L_go2830
  s_waitcnt vmcnt(3)
L_go2830:
  buffer_load_dwordx4 v[212:215], v2, s[32:35], s75 offen offset:1024 nt
  s_waitcnt vmcnt(7)
  s_cmpk_lt_i32 s42, -413
  s_cbranch_scc1 L_go2845
  s_waitcnt vmcnt(6)
  s_cmpk_lt_i32 s42, -263
  s_cbranch_scc1 L_go2845
  s_waitcnt vmcnt(5)
  s_cmpk_lt_i32 s42, -113
  s_cbranch_scc1 L_go2845
  s_waitcnt vmcnt(4)
  s_cmpk_lt_i32 s42, 37
  s_cbranch_scc1 L_go2845
  s_waitcnt vmcnt(3)
L_go2845:
  buffer_load_dwordx4 v[216:219], v2, s[32:35], s75 offen offset:2048 nt
  s_waitcnt vmcnt(7)
  s_cmpk_lt_i32 s42, -338
  s_cbranch_scc1 L_go2860
  s_waitcnt vmcnt(6)
  s_cmpk_lt_i32 s42, -188
  s_cbranch_scc1 L_go2860
  s_waitcnt vmcnt(5)
  s_cmpk_lt_i32 s42, -38
  s_cbranch_scc1 L_go2860
  s_waitcnt vmcnt(4)
  s_cmpk_lt_i32 s42, 112
  s_cbranch_scc1 L_go2860
  s_waitcnt vmcnt(3)
L_go2860:
  buffer_load_dwordx4 v[220:223], v2, s[32:35], s75 offen offset:3072 nt
  s_add_u32 s75, s75, 16384
  v_mov_b32_dpp v58, v24 quad_perm:[0,0,0,0] row_mask:0xf bank_mask:0xf
  v_add_f32_dpp v58, v25, v58 quad_perm:[1,1,1,1] row_mask:0xf bank_mask:0xf
  v_add_f32_dpp v58, v26, v58 quad_perm:[2,2,2,2] row_mask:0xf bank_mask:0xf
  v_add_f32_dpp v58, v27, v58 quad_perm:[3,3,3,3] row_mask:0xf bank_mask:0xf
  v_cvt_pk_bf16_f32 v58, v58, v58
  v_and_b32 v58, s82, v58
  v_mul_f32 v58, s80, v58
  v_cvt_pk_bf16_f32 v58, v58, v58
  v_and_b32 v58, s82, v58
  ds_write_b32 v56, v58 offset:4
  v_max_f32 v34, v34, v58
  s_waitcnt vmcnt(12)
  v_mfma_f32_16x16x32_bf16 v[24:27], v[224:227], v[8:11], 0
  v_mfma_f32_16x16x32_bf16 v[24:27], v[228:231], v[12:15], v[24:27]
  v_mfma_f32_16x16x32_bf16 v[24:27], v[232:235], v[16:19], v[24:27]
  v_mfma_f32_16x16x32_bf16 v[24:27], v[236:239], v[20:23], v[24:27]
  s_waitcnt vmcnt(7)
  s_cmpk_lt_i32 s42, -450
  s_cbranch_scc1 L_go2892
  s_waitcnt vmcnt(6)
  s_cmpk_lt_i32 s42, -300
  s_cbranch_scc1 L_go2892
  s_waitcnt vmcnt(5)
  s_cmpk_lt_i32 s42, -150
  s_cbranch_scc1 L_go2892
  s_waitcnt vmcnt(4)
  s_cmpk_lt_i32 s42, 0
  s_cbranch_scc1 L_go2892
  s_waitcnt vmcnt(3)
L_go2892:
  buffer_load_dwordx4 v[224:227], v2, s[32:35], s75 offen offset:0 nt
  s_waitcnt vmcnt(7)
  s_cmpk_lt_i32 s42, -375
  s_cbranch_scc1 L_go2907
  s_waitcnt vmcnt(6)
  s_cmpk_lt_i32 s42, -225
  s_cbranch_scc1 L_go2907
  s_waitcnt vmcnt(5)
  s_cmpk_lt_i32 s42, -75
  s_cbranch_scc1 L_go2907
  s_waitcnt vmcnt(4)
  s_cmpk_lt_i32 s42, 75
  s_cbranch_scc1 L_go2907
  s_waitcnt vmcnt(3)
L_go2907:
  buffer_load_dwordx4 v[228:231], v2, s[32:35], s75 offen offset:1024 nt
  s_waitcnt vmcnt(7)
  s_cmpk_lt_i32 s42, -413
  s_cbranch_scc1 L_go2922
  s_waitcnt vmcnt(6)
  s_cmpk_lt_i32 s42, -263
  s_cbranch_scc1 L_go2922
  s_waitcnt vmcnt(5)
  s_cmpk_lt_i32 s42, -113
  s_cbranch_scc1 L_go2922
  s_waitcnt vmcnt(4)
  s_cmpk_lt_i32 s42, 37
  s_cbranch_scc1 L_go2922
  s_waitcnt vmcnt(3)
L_go2922:
  buffer_load_dwordx4 v[232:235], v2, s[32:35], s75 offen offset:2048 nt
  s_waitcnt vmcnt(7)
  s_cmpk_lt_i32 s42, -338
  s_cbranch_scc1 L_go2937
  s_waitcnt vmcnt(6)
  s_cmpk_lt_i32 s42, -188
  s_cbranch_scc1 L_go2937
  s_waitcnt vmcnt(5)
  s_cmpk_lt_i32 s42, -38
  s_cbranch_scc1 L_go2937
  s_waitcnt vmcnt(4)
  s_cmpk_lt_i32 s42, 112
  s_cbranch_scc1 L_go2937
  s_waitcnt vmcnt(3)
L_go2937:
  buffer_load_dwordx4 v[236:239], v2, s[32:35], s75 offen offset:3072 nt
  s_add_u32 s75, s75, 16384
  v_mov_b32_dpp v58, v24 quad_perm:[0,0,0,0] row_mask:0xf bank_mask:0xf
  v_add_f32_dpp v58, v25, v58 quad_perm:[1,1,1,1] row_mask:0xf bank_mask:0xf
  v_add_f32_dpp v58, v26, v58 quad_perm:[2,2,2,2] row_mask:0xf bank_mask:0xf
  v_add_f32_dpp v58, v27, v58 quad_perm:[3,3,3,3] row_mask:0xf bank_mask:0xf
  v_cvt_pk_bf16_f32 v58, v58, v58
  v_and_b32 v58, s82, v58
  v_mul_f32 v58, s80, v58
  v_cvt_pk_bf16_f32 v58, v58, v58
  v_and_b32 v58, s82, v58
  ds_write_b32 v56, v58 offset:8
  v_max_f32 v34, v34, v58
  s_waitcnt vmcnt(12)
  v_mfma_f32_16x16x32_bf16 v[24:27], v[240:243], v[8:11], 0
  v_mfma_f32_16x16x32_bf16 v[24:27], v[244:247], v[12:15], v[24:27]
  v_mfma_f32_16x16x32_bf16 v[24:27], v[248:251], v[16:19], v[24:27]
  v_mfma_f32_16x16x32_bf16 v[24:27], v[252:255], v[20:23], v[24:27]
  s_waitcnt vmcnt(7)
  s_cmpk_lt_i32 s42, -450
  s_cbranch_scc1 L_go2969
  s_waitcnt vmcnt(6)
  s_cmpk_lt_i32 s42, -300
  s_cbranch_scc1 L_go2969
  s_waitcnt vmcnt(5)
  s_cmpk_lt_i32 s42, -150
  s_cbranch_scc1 L_go2969
  s_waitcnt vmcnt(4)
  s_cmpk_lt_i32 s42, 0
  s_cbranch_scc1 L_go2969
  s_waitcnt vmcnt(3)
L_go2969:
  buffer_load_dwordx4 v[240:243], v2, s[32:35], s75 offen offset:0 nt
  s_waitcnt vmcnt(7)
  s_cmpk_lt_i32 s42, -375
  s_cbranch_scc1 L_go2984
  s_waitcnt vmcnt(6)
  s_cmpk_lt_i32 s42, -225
  s_cbranch_scc1 L_go2984
  s_waitcnt vmcnt(5)
  s_cmpk_lt_i32 s42, -75
  s_cbranch_scc1 L_go2984
  s_waitcnt vmcnt(4)
  s_cmpk_lt_i32 s42, 75
  s_cbranch_scc1 L_go2984
  s_waitcnt vmcnt(3)
L_go2984:
  buffer_load_dwordx4 v[244:247], v2, s[32:35], s75 offen offset:1024 nt
  s_waitcnt vmcnt(7)
  s_cmpk_lt_i32 s42, -413
  s_cbranch_scc1 L_go2999
  s_waitcnt vmcnt(6)
  s_cmpk_lt_i32 s42, -263
  s_cbranch_scc1 L_go2999
  s_waitcnt vmcnt(5)
  s_cmpk_lt_i32 s42, -113
  s_cbranch_scc1 L_go2999
  s_waitcnt vmcnt(4)
  s_cmpk_lt_i32 s42, 37
  s_cbranch_scc1 L_go2999
  s_waitcnt vmcnt(3)
L_go2999:
  buffer_load_dwordx4 v[248:251], v2, s[32:35], s75 offen offset:2048 nt
  s_waitcnt vmcnt(7)
  s_cmpk_lt_i32 s42, -338
  s_cbranch_scc1 L_go3014
  s_waitcnt vmcnt(6)
  s_cmpk_lt_i32 s42, -188
  s_cbranch_scc1 L_go3014
  s_waitcnt vmcnt(5)
  s_cmpk_lt_i32 s42, -38
  s_cbranch_scc1 L_go3014
  s_waitcnt vmcnt(4)
  s_cmpk_lt_i32 s42, 112
  s_cbranch_scc1 L_go3014
  s_waitcnt vmcnt(3)
L_go3014:
  s_memrealtime s[40:41]
  buffer_load_dwordx4 v[252:255], v2, s[32:35], s75 offen offset:3072 nt
  s_add_u32 s75, s75, 81920
  v_mov_b32_dpp v58, v24 quad_perm:[0,0,0,0] row_mask:0xf bank_mask:0xf
  v_add_f32_dpp v58, v25, v58 quad_perm:[1,1,1,1] row_mask:0xf bank_mask:0xf
  v_add_f32_dpp v58, v26, v58 quad_perm:[2,2,2,2] row_mask:0xf bank_mask:0xf
  v_add_f32_dpp v58, v27, v58 quad_perm:[3,3,3,3] row_mask:0xf bank_mask:0xf
  v_cvt_pk_bf16_f32 v58, v58, v58
  v_and_b32 v58, s82, v58
  v_mul_f32 v58, s80, v58
  v_cvt_pk_bf16_f32 v58, v58, v58
  v_and_b32 v58, s82, v58
  ds_write_b32 v56, v58 offset:12
  v_max_f32 v34, v34, v58
  v_add_u32 v56, 256, v56
  s_add_u32 s88, s88, 1
  s_cmp_lg_u32 s88, s45
  s_cbranch_scc1 L_k
  s_cmp_lg_u32 s88, 15
  s_cbranch_scc1 L_e1
  s_mov_b32 s45, 16
  s_add_u32 s75, s75, 266338304
  ds_read_b128 v[40:43], v59 offset:34816
  ds_read_b128 v[44:47], v59 offset:34832
  s_branch L_k
L_e1:
  s_cmp_lg_u32 s88, 16
  s_cbranch_scc1 L_e2
  s_mov_b32 s45, 31
  v_mov_b32 v32, v34
  v_mov_b32 v34, 0xff800000
  s_branch L_qbuild
L_e2:
  s_cmp_lg_u32 s88, 31
  s_cbranch_scc1 L_e3
  s_mov_b32 s45, 32
  s_mov_b32 s32, s36
  s_mov_b32 s33, s37
  s_mov_b32 s34, s38
  s_mov_b32 s35, s39
  s_mov_b32 s75, s76
  v_mov_b32 v2, v3
  ds_read_b32 v0, v63 offset:41920
  s_branch L_k
L_e3:
  v_readfirstlane_b32 s77, v0
  s_nop 0
  s_add_u32 s78, s77, 10
  s_sub_u32 s78, s78, s94
  s_max_i32 s78, s78, -60
  s_min_i32 s78, s78, 30
  s_add_u32 s78, s78, s94
  s_cmp_lg_u32 s77, 0
  s_cselect_b32 s94, s78, s94
  s_mov_b32 s45, 47
  ds_read_b128 v[48:51], v57 offset:0
  ds_read_b128 v[8:11], v57 offset:4096
  v_max_f32_dpp v32, v32, v32 row_ror:4 row_mask:0xf bank_mask:0xf
  v_max_f32_dpp v34, v34, v34 row_ror:4 row_mask:0xf bank_mask:0xf
  s_nop 0
  v_max_f32_dpp v32, v32, v32 row_ror:8 row_mask:0xf bank_mask:0xf
  v_max_f32_dpp v34, v34, v34 row_ror:8 row_mask:0xf bank_mask:0xf
  v_readlane_b32 s84, v32, 0
  v_readlane_b32 s85, v32, 16
  v_readlane_b32 s86, v32, 32
  v_readlane_b32 s87, v32, 48
  v_readlane_b32 s52, v34, 0
  v_readlane_b32 s53, v34, 16
  v_readlane_b32 s54, v34, 32
  v_readlane_b32 s55, v34, 48
  v_mov_b32 v32, s84
  v_mov_b32 v34, s52
  v_max_f32 v32, s85, v32
  v_max_f32 v34, s53, v34
  v_max_f32 v32, s86, v32
  v_max_f32 v34, s54, v34
  v_max_f32 v32, s87, v32
  v_max_f32 v34, s55, v34
  v_mul_f32 v16, s83, v32
  v_mul_f32 v17, s83, v34
  s_mov_b64 vcc, 0
L_v:
  s_waitcnt lgkmcnt(0)
  s_ashr_i32 s79, s43, 4
  s_sub_u32 s79, s79, s40
  s_add_u32 s43, s43, 3462
  s_add_u32 s42, s79, s94
  v_fma_f32 v52, v48, s81, v16
  v_fma_f32 v53, v49, s81, v16
  v_fma_f32 v54, v50, s81, v16
  v_fma_f32 v55, v51, s81, v16
  ds_read_b128 v[48:51], v57 offset:256
  v_exp_f32 v52, v52
  v_exp_f32 v53, v53
  v_exp_f32 v54, v54
  v_exp_f32 v55, v55
  v_cvt_pk_bf16_f32 v36, v52, v52
  v_cvt_pk_bf16_f32 v37, v53, v53
  v_cvt_pk_bf16_f32 v38, v54, v54
  v_cvt_pk_bf16_f32 v39, v55, v55
  v_and_b32_dpp v64, v36, v4 row_newbcast:0 row_mask:0xf bank_mask:0xf
  v_and_b32_dpp v65, v36, v5 row_newbcast:0 row_mask:0xf bank_mask:0xf
  v_and_b32_dpp v66, v36, v6 row_newbcast:0 row_mask:0xf bank_mask:0xf
  v_and_b32_dpp v67, v36, v7 row_newbcast:0 row_mask:0xf bank_mask:0xf
  s_waitcnt vmcnt(12)
  v_and_b32_dpp v68, v36, v4 row_newbcast:4 row_mask:0xf bank_mask:0xf
  v_and_b32_dpp v69, v36, v5 row_newbcast:4 row_mask:0xf bank_mask:0xf
  v_and_b32_dpp v70, v36, v6 row_newbcast:4 row_mask:0xf bank_mask:0xf
  v_and_b32_dpp v71, v36, v7 row_newbcast:4 row_mask:0xf bank_mask:0xf
  v_mfma_f32_16x16x32_bf16 v[28:31], v[192:195], v[64:67], v[28:31]
  v_and_b32_dpp v72, v36, v4 row_newbcast:8 row_mask:0xf bank_mask:0xf
  v_and_b32_dpp v73, v36, v5 row_newbcast:8 row_mask:0xf bank_mask:0xf
  v_and_b32_dpp v74, v36, v6 row_newbcast:8 row_mask:0xf bank_mask:0xf
  v_and_b32_dpp v75, v36, v7 row_newbcast:8 row_mask:0xf bank_mask:0xf
  v_mfma_f32_16x16x32_bf16 v[28:31], v[196:199], v[68:71], v[28:31]
  v_and_b32_dpp v76, v36, v4 row_newbcast:12 row_mask:0xf bank_mask:0xf
  v_and_b32_dpp v77, v36, v5 row_newbcast:12 row_mask:0xf bank_mask:0xf
  v_and_b32_dpp v78, v36, v6 row_newbcast:12 row_mask:0xf bank_mask:0xf
  v_and_b32_dpp v79, v36, v7 row_newbcast:12 row_mask:0xf bank_mask:0xf
  v_mfma_f32_16x16x32_bf16 v[28:31], v[200:203], v[72:75], v[28:31]
  s_nop 0
  v_mfma_f32_16x16x32_bf16 v[28:31], v[204:207], v[76:79], v[28:31]
  s_waitcnt vmcnt(7)
  s_cmpk_lt_i32 s42, -450
  s_cbranch_scc1 L_go3147
  s_waitcnt vmcnt(6)
  s_cmpk_lt_i32 s42, -300
  s_cbranch_scc1 L_go3147
  s_waitcnt vmcnt(5)
  s_cmpk_lt_i32 s42, -150
  s_cbranch_scc1 L_go3147
  s_waitcnt vmcnt(4)
  s_cmpk_lt_i32 s42, 0
  s_cbranch_scc1 L_go3147
  s_waitcnt vmcnt(3)
L_go3147:
  buffer_load_dwordx4 v[192:195], v2, s[32:35], s75 offen offset:0 nt
  s_waitcnt vmcnt(7)
  s_cmpk_lt_i32 s42, -375
  s_cbranch_scc1 L_go3162
  s_waitcnt vmcnt(6)
  s_cmpk_lt_i32 s42, -225
  s_cbranch_scc1 L_go3162
  s_waitcnt vmcnt(5)
  s_cmpk_lt_i32 s42, -75
  s_cbranch_scc1 L_go3162
  s_waitcnt vmcnt(4)
  s_cmpk_lt_i32 s42, 75
  s_cbranch_scc1 L_go3162
  s_waitcnt vmcnt(3)
L_go3162:
  buffer_load_dwordx4 v[196:199], v2, s[32:35], s75 offen offset:1024 nt
  s_waitcnt vmcnt(7)
  s_cmpk_lt_i32 s42, -413
  s_cbranch_scc1 L_go3177
  s_waitcnt vmcnt(6)
  s_cmpk_lt_i32 s42, -263
  s_cbranch_scc1 L_go3177
  s_waitcnt vmcnt(5)
  s_cmpk_lt_i32 s42, -113
  s_cbranch_scc1 L_go3177
  s_waitcnt vmcnt(4)
  s_cmpk_lt_i32 s42, 37
  s_cbranch_scc1 L_go3177
  s_waitcnt vmcnt(3)
L_go3177:
  buffer_load_dwordx4 v[200:203], v2, s[32:35], s75 offen offset:2048 nt
  s_waitcnt vmcnt(7)
  s_cmpk_lt_i32 s42, -338
  s_cbranch_scc1 L_go3192
  s_waitcnt vmcnt(6)
  s_cmpk_lt_i32 s42, -188
  s_cbranch_scc1 L_go3192
  s_waitcnt vmcnt(5)
  s_cmpk_lt_i32 s42, -38
  s_cbranch_scc1 L_go3192
  s_waitcnt vmcnt(4)
  s_cmpk_lt_i32 s42, 112
  s_cbranch_scc1 L_go3192
  s_waitcnt vmcnt(3)
L_go3192:
  buffer_load_dwordx4 v[204:207], v2, s[32:35], s75 offen offset:3072 nt
  s_add_u32 s75, s75, 16384
  v_add_f32 v52, v52, v53
  v_add_f32 v54, v54, v55
  v_add_f32 v33, v33, v52
  v_add_f32 v33, v33, v54
  v_and_b32_dpp v64, v37, v4 row_newbcast:0 row_mask:0xf bank_mask:0xf
  v_and_b32_dpp v65, v37, v5 row_newbcast:0 row_mask:0xf bank_mask:0xf
  v_and_b32_dpp v66, v37, v6 row_newbcast:0 row_mask:0xf bank_mask:0xf
  v_and_b32_dpp v67, v37, v7 row_newbcast:0 row_mask:0xf bank_mask:0xf
  s_waitcnt vmcnt(12)
  v_and_b32_dpp v68, v37, v4 row_newbcast:4 row_mask:0xf bank_mask:0xf
  v_and_b32_dpp v69, v37, v5 row_newbcast:4 row_mask:0xf bank_mask:0xf
  v_and_b32_dpp v70, v37, v6 row_newbcast:4 row_mask:0xf bank_mask:0xf
  v_and_b32_dpp v71, v37, v7 row_newbcast:4 row_mask:0xf bank_mask:0xf
  v_mfma_f32_16x16x32_bf16 v[28:31], v[208:211], v[64:67], v[28:31]
  v_and_b32_dpp v72, v37, v4 row_newbcast:8 row_mask:0xf bank_mask:0xf
  v_and_b32_dpp v73, v37, v5 row_newbcast:8 row_mask:0xf bank_mask:0xf
  v_and_b32_dpp v74, v37, v6 row_newbcast:8 row_mask:0xf bank_mask:0xf
  v_and_b32_dpp v75, v37, v7 row_newbcast:8 row_mask:0xf bank_mask:0xf
  v_mfma_f32_16x16x32_bf16 v[28:31], v[212:215], v[68:71], v[28:31]
  v_and_b32_dpp v76, v37, v4 row_newbcast:12 row_mask:0xf bank_mask:0xf
  v_and_b32_dpp v77, v37, v5 row_newbcast:12 row_mask:0xf bank_mask:0xf
  v_and_b32_dpp v78, v37, v6 row_newbcast:12 row_mask:0xf bank_mask:0xf
  v_and_b32_dpp v79, v37, v7 row_newbcast:12 row_mask:0xf bank_mask:0xf
  v_mfma_f32_16x16x32_bf16 v[28:31], v[216:219], v[72:75], v[28:31]
  s_nop 0
  v_mfma_f32_16x16x32_bf16 v[28:31], v[220:223], v[76:79], v[28:31]
  s_waitcnt vmcnt(7)
  s_cmpk_lt_i32 s42, -450
  s_cbranch_scc1 L_go3233
  s_waitcnt vmcnt(6)
  s_cmpk_lt_i32 s42, -300
  s_cbranch_scc1 L_go3233
  s_waitcnt vmcnt(5)
  s_cmpk_lt_i32 s42, -150
  s_cbranch_scc1 L_go3233
  s_waitcnt vmcnt(4)
  s_cmpk_lt_i32 s42, 0
  s_cbranch_scc1 L_go3233
  s_waitcnt vmcnt(3)
L_go3233:
  buffer_load_dwordx4 v[208:211], v2, s[32:35], s75 offen offset:0 nt
  s_waitcnt vmcnt(7)
  s_cmpk_lt_i32 s42, -375
  s_cbranch_scc1 L_go3248
  s_waitcnt vmcnt(6)
  s_cmpk_lt_i32 s42, -225
  s_cbranch_scc1 L_go3248
  s_waitcnt vmcnt(5)
  s_cmpk_lt_i32 s42, -75
  s_cbranch_scc1 L_go3248
  s_waitcnt vmcnt(4)
  s_cmpk_lt_i32 s42, 75
  s_cbranch_scc1 L_go3248
  s_waitcnt vmcnt(3)
L_go3248:
  buffer_load_dwordx4 v[212:215], v2, s[32:35], s75 offen offset:1024 nt
  s_waitcnt vmcnt(7)
  s_cmpk_lt_i32 s42, -413
  s_cbranch_scc1 L_go3263
  s_waitcnt vmcnt(6)
  s_cmpk_lt_i32 s42, -263
  s_cbranch_scc1 L_go3263
  s_waitcnt vmcnt(5)
  s_cmpk_lt_i32 s42, -113
  s_cbranch_scc1 L_go3263
  s_waitcnt vmcnt(4)
  s_cmpk_lt_i32 s42, 37
  s_cbranch_scc1 L_go3263
  s_waitcnt vmcnt(3)
L_go3263:
  buffer_load_dwordx4 v[216:219], v2, s[32:35], s75 offen offset:2048 nt
  s_waitcnt vmcnt(7)
  s_cmpk_lt_i32 s42, -338
  s_cbranch_scc1 L_go3278
  s_waitcnt vmcnt(6)
  s_cmpk_lt_i32 s42, -188
  s_cbranch_scc1 L_go3278
  s_waitcnt vmcnt(5)
  s_cmpk_lt_i32 s42, -38
  s_cbranch_scc1 L_go3278
  s_waitcnt vmcnt(4)
  s_cmpk_lt_i32 s42, 112
  s_cbranch_scc1 L_go3278
  s_waitcnt vmcnt(3)
L_go3278:
  buffer_load_dwordx4 v[220:223], v2, s[32:35], s75 offen offset:3072 nt
  s_add_u32 s75, s75, 16384
  v_fma_f32 v12, v8, s81, v17
  v_fma_f32 v13, v9, s81, v17
  v_fma_f32 v14, v10, s81, v17
  v_fma_f32 v15, v11, s81, v17
  ds_read_b128 v[8:11], v57 offset:4352
  v_exp_f32 v12, v12
  v_exp_f32 v13, v13
  v_exp_f32 v14, v14
  v_exp_f32 v15, v15
  v_and_b32_dpp v64, v38, v4 row_newbcast:0 row_mask:0xf bank_mask:0xf
  v_and_b32_dpp v65, v38, v5 row_newbcast:0 row_mask:0xf bank_mask:0xf
  v_and_b32_dpp v66, v38, v6 row_newbcast:0 row_mask:0xf bank_mask:0xf
  v_and_b32_dpp v67, v38, v7 row_newbcast:0 row_mask:0xf bank_mask:0xf
  s_waitcnt vmcnt(12)
  v_and_b32_dpp v68, v38, v4 row_newbcast:4 row_mask:0xf bank_mask:0xf
  v_and_b32_dpp v69, v38, v5 row_newbcast:4 row_mask:0xf bank_mask:0xf
  v_and_b32_dpp v70, v38, v6 row_newbcast:4 row_mask:0xf bank_mask:0xf
  v_and_b32_dpp v71, v38, v7 row_newbcast:4 row_mask:0xf bank_mask:0xf
  v_mfma_f32_16x16x32_bf16 v[28:31], v[224:227], v[64:67], v[28:31]
  v_and_b32_dpp v72, v38, v4 row_newbcast:8 row_mask:0xf bank_mask:0xf
  v_and_b32_dpp v73, v38, v5 row_newbcast:8 row_mask:0xf bank_mask:0xf
  v_and_b32_dpp v74, v38, v6 row_newbcast:8 row_mask:0xf bank_mask:0xf
  v_and_b32_dpp v75, v38, v7 row_newbcast:8 row_mask:0xf bank_mask:0xf
  v_mfma_f32_16x16x32_bf16 v[28:31], v[228:231], v[68:71], v[28:31]
  v_and_b32_dpp v76, v38, v4 row_newbcast:12 row_mask:0xf bank_mask:0xf
  v_and_b32_dpp v77, v38, v5 row_newbcast:12 row_mask:0xf bank_mask:0xf
  v_and_b32_dpp v78, v38, v6 row_newbcast:12 row_mask:0xf bank_mask:0xf
  v_and_b32_dpp v79, v38, v7 row_newbcast:12 row_mask:0xf bank_mask:0xf
  v_mfma_f32_16x16x32_bf16 v[28:31], v[232:235], v[72:75], v[28:31]
  s_nop 0
  v_mfma_f32_16x16x32_bf16 v[28:31], v[236:239], v[76:79], v[28:31]
  s_waitcnt vmcnt(7)
  s_cmpk_lt_i32 s42, -450
  s_cbranch_scc1 L_go3324
  s_waitcnt vmcnt(6)
  s_cmpk_lt_i32 s42, -300
  s_cbranch_scc1 L_go3324
  s_waitcnt vmcnt(5)
  s_cmpk_lt_i32 s42, -150
  s_cbranch_scc1 L_go3324
  s_waitcnt vmcnt(4)
  s_cmpk_lt_i32 s42, 0
  s_cbranch_scc1 L_go3324
  s_waitcnt vmcnt(3)
L_go3324:
  buffer_load_dwordx4 v[224:227], v2, s[32:35], s75 offen offset:0 nt
  s_waitcnt vmcnt(7)
  s_cmpk_lt_i32 s42, -375
  s_cbranch_scc1 L_go3339
  s_waitcnt vmcnt(6)
  s_cmpk_lt_i32 s42, -225
  s_cbranch_scc1 L_go3339
  s_waitcnt vmcnt(5)
  s_cmpk_lt_i32 s42, -75
  s_cbranch_scc1 L_go3339
  s_waitcnt vmcnt(4)
  s_cmpk_lt_i32 s42, 75
  s_cbranch_scc1 L_go3339
  s_waitcnt vmcnt(3)
L_go3339:
  buffer_load_dwordx4 v[228:231], v2, s[32:35], s75 offen offset:1024 nt
  s_waitcnt vmcnt(7)
  s_cmpk_lt_i32 s42, -413
  s_cbranch_scc1 L_go3354
  s_waitcnt vmcnt(6)
  s_cmpk_lt_i32 s42, -263
  s_cbranch_scc1 L_go3354
  s_waitcnt vmcnt(5)
  s_cmpk_lt_i32 s42, -113
  s_cbranch_scc1 L_go3354
  s_waitcnt vmcnt(4)
  s_cmpk_lt_i32 s42, 37
  s_cbranch_scc1 L_go3354
  s_waitcnt vmcnt(3)
L_go3354:
  buffer_load_dwordx4 v[232:235], v2, s[32:35], s75 offen offset:2048 nt
  s_waitcnt vmcnt(7)
  s_cmpk_lt_i32 s42, -338
  s_cbranch_scc1 L_go3369
  s_waitcnt vmcnt(6)
  s_cmpk_lt_i32 s42, -188
  s_cbranch_scc1 L_go3369
  s_waitcnt vmcnt(5)
  s_cmpk_lt_i32 s42, -38
  s_cbranch_scc1 L_go3369
  s_waitcnt vmcnt(4)
  s_cmpk_lt_i32 s42, 112
  s_cbranch_scc1 L_go3369
  s_waitcnt vmcnt(3)
L_go3369:
  buffer_load_dwordx4 v[236:239], v2, s[32:35], s75 offen offset:3072 nt
  s_add_u32 s75, s75, 16384
  v_add_f32 v12, v12, v13
  v_add_f32 v14, v14, v15
  v_add_f32 v35, v35, v12
  v_add_f32 v35, v35, v14
  v_and_b32_dpp v64, v39, v4 row_newbcast:0 row_mask:0xf bank_mask:0xf
  v_and_b32_dpp v65, v39, v5 row_newbcast:0 row_mask:0xf bank_mask:0xf
  v_and_b32_dpp v66, v39, v6 row_newbcast:0 row_mask:0xf bank_mask:0xf
  v_and_b32_dpp v67, v39, v7 row_newbcast:0 row_mask:0xf bank_mask:0xf
  s_waitcnt vmcnt(12)
  v_and_b32_dpp v68, v39, v4 row_newbcast:4 row_mask:0xf bank_mask:0xf
  v_and_b32_dpp v69, v39, v5 row_newbcast:4 row_mask:0xf bank_mask:0xf
  v_and_b32_dpp v70, v39, v6 row_newbcast:4 row_mask:0xf bank_mask:0xf
  v_and_b32_dpp v71, v39, v7 row_newbcast:4 row_mask:0xf bank_mask:0xf
  v_mfma_f32_16x16x32_bf16 v[28:31], v[240:243], v[64:67], v[28:31]
  v_and_b32_dpp v72, v39, v4 row_newbcast:8 row_mask:0xf bank_mask:0xf
  v_and_b32_dpp v73, v39, v5 row_newbcast:8 row_mask:0xf bank_mask:0xf
  v_and_b32_dpp v74, v39, v6 row_newbcast:8 row_mask:0xf bank_mask:0xf
  v_and_b32_dpp v75, v39, v7 row_newbcast:8 row_mask:0xf bank_mask:0xf
  v_mfma_f32_16x16x32_bf16 v[28:31], v[244:247], v[68:71], v[28:31]
  v_and_b32_dpp v76, v39, v4 row_newbcast:12 row_mask:0xf bank_mask:0xf
  v_and_b32_dpp v77, v39, v5 row_newbcast:12 row_mask:0xf bank_mask:0xf
  v_and_b32_dpp v78, v39, v6 row_newbcast:12 row_mask:0xf bank_mask:0xf
  v_and_b32_dpp v79, v39, v7 row_newbcast:12 row_mask:0xf bank_mask:0xf
  v_mfma_f32_16x16x32_bf16 v[28:31], v[248:251], v[72:75], v[28:31]
  s_nop 0
  v_mfma_f32_16x16x32_bf16 v[28:31], v[252:255], v[76:79], v[28:31]
  s_waitcnt vmcnt(7)
  s_cmpk_lt_i32 s42, -450
  s_cbranch_scc1 L_go3410
  s_waitcnt vmcnt(6)
  s_cmpk_lt_i32 s42, -300
  s_cbranch_scc1 L_go3410
  s_waitcnt vmcnt(5)
  s_cmpk_lt_i32 s42, -150
  s_cbranch_scc1 L_go3410
  s_waitcnt vmcnt(4)
  s_cmpk_lt_i32 s42, 0
  s_cbranch_scc1 L_go3410
  s_waitcnt vmcnt(3)
L_go3410:
  buffer_load_dwordx4 v[240:243], v2, s[32:35], s75 offen offset:0 nt
  s_waitcnt vmcnt(7)
  s_cmpk_lt_i32 s42, -375
  s_cbranch_scc1 L_go3425
  s_waitcnt vmcnt(6)
  s_cmpk_lt_i32 s42, -225
  s_cbranch_scc1 L_go3425
  s_waitcnt vmcnt(5)
  s_cmpk_lt_i32 s42, -75
  s_cbranch_scc1 L_go3425
  s_waitcnt vmcnt(4)
  s_cmpk_lt_i32 s42, 75
  s_cbranch_scc1 L_go3425
  s_waitcnt vmcnt(3)
L_go3425:
  buffer_load_dwordx4 v[244:247], v2, s[32:35], s75 offen offset:1024 nt
  s_waitcnt vmcnt(7)
  s_cmpk_lt_i32 s42, -413
  s_cbranch_scc1 L_go3440
  s_waitcnt vmcnt(6)
  s_cmpk_lt_i32 s42, -263
  s_cbranch_scc1 L_go3440
  s_waitcnt vmcnt(5)
  s_cmpk_lt_i32 s42, -113
  s_cbranch_scc1 L_go3440
  s_waitcnt vmcnt(4)
  s_cmpk_lt_i32 s42, 37
  s_cbranch_scc1 L_go3440
  s_waitcnt vmcnt(3)
L_go3440:
  buffer_load_dwordx4 v[248:251], v2, s[32:35], s75 offen offset:2048 nt
  s_waitcnt vmcnt(7)
  s_cmpk_lt_i32 s42, -338
  s_cbranch_scc1 L_go3455
  s_waitcnt vmcnt(6)
  s_cmpk_lt_i32 s42, -188
  s_cbranch_scc1 L_go3455
  s_waitcnt vmcnt(5)
  s_cmpk_lt_i32 s42, -38
  s_cbranch_scc1 L_go3455
  s_waitcnt vmcnt(4)
  s_cmpk_lt_i32 s42, 112
  s_cbranch_scc1 L_go3455
  s_waitcnt vmcnt(3)
L_go3455:
  s_memrealtime s[40:41]
  buffer_load_dwordx4 v[252:255], v2, s[32:35], s75 offen offset:3072 nt
  s_add_u32 s75, s75, 81920
  v_add_u32 v57, 256, v57
  s_add_u32 s88, s88, 1
  s_cmp_lg_u32 s88, s45
  s_cbranch_scc1 L_v
  s_cmp_lg_u32 s88, 63
  s_cbranch_scc1 L_e4
  s_mov_b64 vcc, -1
  s_waitcnt lgkmcnt(0)
  v_fma_f32 v52, v48, s81, v16
  v_fma_f32 v53, v49, s81, v16
  v_fma_f32 v54, v50, s81, v16
  v_fma_f32 v55, v51, s81, v16
  v_exp_f32 v52, v52
  v_exp_f32 v53, v53
  v_exp_f32 v54, v54
  v_exp_f32 v55, v55
  v_cvt_pk_bf16_f32 v36, v52, v52
  v_cvt_pk_bf16_f32 v37, v53, v53
  v_cvt_pk_bf16_f32 v38, v54, v54
  v_cvt_pk_bf16_f32 v39, v55, v55
  v_and_b32_dpp v64, v36, v4 row_newbcast:0 row_mask:0xf bank_mask:0xf
  v_and_b32_dpp v65, v36, v5 row_newbcast:0 row_mask:0xf bank_mask:0xf
  v_and_b32_dpp v66, v36, v6 row_newbcast:0 row_mask:0xf bank_mask:0xf
  v_and_b32_dpp v67, v36, v7 row_newbcast:0 row_mask:0xf bank_mask:0xf
  v_and_b32_dpp v68, v36, v4 row_newbcast:4 row_mask:0xf bank_mask:0xf
  v_and_b32_dpp v69, v36, v5 row_newbcast:4 row_mask:0xf bank_mask:0xf
  v_and_b32_dpp v70, v36, v6 row_newbcast:4 row_mask:0xf bank_mask:0xf
  v_and_b32_dpp v71, v36, v7 row_newbcast:4 row_mask:0xf bank_mask:0xf
  v_and_b32_dpp v72, v36, v4 row_newbcast:8 row_mask:0xf bank_mask:0xf
  v_and_b32_dpp v73, v36, v5 row_newbcast:8 row_mask:0xf bank_mask:0xf
  v_and_b32_dpp v74, v36, v6 row_newbcast:8 row_mask:0xf bank_mask:0xf
  v_and_b32_dpp v75, v36, v7 row_newbcast:8 row_mask:0xf bank_mask:0xf
  v_and_b32_dpp v76, v36, v4 row_newbcast:12 row_mask:0xf bank_mask:0xf
  v_and_b32_dpp v77, v36, v5 row_newbcast:12 row_mask:0xf bank_mask:0xf
  v_and_b32_dpp v78, v36, v6 row_newbcast:12 row_mask:0xf bank_mask:0xf
  v_and_b32_dpp v79, v36, v7 row_newbcast:12 row_mask:0xf bank_mask:0xf
  v_and_b32_dpp v80, v37, v4 row_newbcast:0 row_mask:0xf bank_mask:0xf
  v_and_b32_dpp v81, v37, v5 row_newbcast:0 row_mask:0xf bank_mask:0xf
  v_and_b32_dpp v82, v37, v6 row_newbcast:0 row_mask:0xf bank_mask:0xf
  v_and_b32_dpp v83, v37, v7 row_newbcast:0 row_mask:0xf bank_mask:0xf
  v_and_b32_dpp v84, v37, v4 row_newbcast:4 row_mask:0xf bank_mask:0xf
  v_and_b32_dpp v85, v37, v5 row_newbcast:4 row_mask:0xf bank_mask:0xf
  v_and_b32_dpp v86, v37, v6 row_newbcast:4 row_mask:0xf bank_mask:0xf
  v_and_b32_dpp v87, v37, v7 row_newbcast:4 row_mask:0xf bank_mask:0xf
  v_and_b32_dpp v88, v37, v4 row_newbcast:8 row_mask:0xf bank_mask:0xf
  v_and_b32_dpp v89, v37, v5 row_newbcast:8 row_mask:0xf bank_mask:0xf
  v_and_b32_dpp v90, v37, v6 row_newbcast:8 row_mask:0xf bank_mask:0xf
  v_and_b32_dpp v91, v37, v7 row_newbcast:8 row_mask:0xf bank_mask:0xf
  v_and_b32_dpp v92, v37, v4 row_newbcast:12 row_mask:0xf bank_mask:0xf
  v_and_b32_dpp v93, v37, v5 row_newbcast:12 row_mask:0xf bank_mask:0xf
  v_and_b32_dpp v94, v37, v6 row_newbcast:12 row_mask:0xf bank_mask:0xf
  v_and_b32_dpp v95, v37, v7 row_newbcast:12 row_mask:0xf bank_mask:0xf
  v_and_b32_dpp v96, v38, v4 row_newbcast:0 row_mask:0xf bank_mask:0xf
  v_and_b32_dpp v97, v38, v5 row_newbcast:0 row_mask:0xf bank_mask:0xf
  v_and_b32_dpp v98, v38, v6 row_newbcast:0 row_mask:0xf bank_mask:0xf
  v_and_b32_dpp v99, v38, v7 row_newbcast:0 row_mask:0xf bank_mask:0xf
  v_and_b32_dpp v100, v38, v4 row_newbcast:4 row_mask:0xf bank_mask:0xf
  v_and_b32_dpp v101, v38, v5 row_newbcast:4 row_mask:0xf bank_mask:0xf
  v_and_b32_dpp v102, v38, v6 row_newbcast:4 row_mask:0xf bank_mask:0xf
  v_and_b32_dpp v103, v38, v7 row_newbcast:4 row_mask:0xf bank_mask:0xf
  v_and_b32_dpp v104, v38, v4 row_newbcast:8 row_mask:0xf bank_mask:0xf
  v_and_b32_dpp v105, v38, v5 row_newbcast:8 row_mask:0xf bank_mask:0xf
  v_and_b32_dpp v106, v38, v6 row_newbcast:8 row_mask:0xf bank_mask:0xf
  v_and_b32_dpp v107, v38, v7 row_newbcast:8 row_mask:0xf bank_mask:0xf
  v_and_b32_dpp v108, v38, v4 row_newbcast:12 row_mask:0xf bank_mask:0xf
  v_and_b32_dpp v109, v38, v5 row_newbcast:12 row_mask:0xf bank_mask:0xf
  v_and_b32_dpp v110, v38, v6 row_newbcast:12 row_mask:0xf bank_mask:0xf
  v_and_b32_dpp v111, v38, v7 row_newbcast:12 row_mask:0xf bank_mask:0xf
  v_and_b32_dpp v112, v39, v4 row_newbcast:0 row_mask:0xf bank_mask:0xf
  v_and_b32_dpp v113, v39, v5 row_newbcast:0 row_mask:0xf bank_mask:0xf
  v_and_b32_dpp v114, v39, v6 row_newbcast:0 row_mask:0xf bank_mask:0xf
  v_and_b32_dpp v115, v39, v7 row_newbcast:0 row_mask:0xf bank_mask:0xf
  v_and_b32_dpp v116, v39, v4 row_newbcast:4 row_mask:0xf bank_mask:0xf
  v_and_b32_dpp v117, v39, v5 row_newbcast:4 row_mask:0xf bank_mask:0xf
  v_and_b32_dpp v118, v39, v6 row_newbcast:4 row_mask:0xf bank_mask:0xf
  v_and_b32_dpp v119, v39, v7 row_newbcast:4 row_mask:0xf bank_mask:0xf
  v_and_b32_dpp v120, v39, v4 row_newbcast:8 row_mask:0xf bank_mask:0xf
  v_and_b32_dpp v121, v39, v5 row_newbcast:8 row_mask:0xf bank_mask:0xf
  v_and_b32_dpp v122, v39, v6 row_newbcast:8 row_mask:0xf bank_mask:0xf
  v_and_b32_dpp v123, v39, v7 row_newbcast:8 row_mask:0xf bank_mask:0xf
  v_and_b32_dpp v124, v39, v4 row_newbcast:12 row_mask:0xf bank_mask:0xf
  v_and_b32_dpp v125, v39, v5 row_newbcast:12 row_mask:0xf bank_mask:0xf
  v_and_b32_dpp v126, v39, v6 row_newbcast:12 row_mask:0xf bank_mask:0xf
  v_and_b32_dpp v127, v39, v7 row_newbcast:12 row_mask:0xf bank_mask:0xf
  s_waitcnt vmcnt(15)
  v_mfma_f32_16x16x32_bf16 v[28:31], v[192:195], v[64:67], v[28:31]
  s_waitcnt vmcnt(14)
  v_mfma_f32_16x16x32_bf16 v[28:31], v[196:199], v[68:71], v[28:31]
  s_waitcnt vmcnt(13)
  v_mfma_f32_16x16x32_bf16 v[28:31], v[200:203], v[72:75], v[28:31]
  s_waitcnt vmcnt(12)
  v_mfma_f32_16x16x32_bf16 v[28:31], v[204:207], v[76:79], v[28:31]
  s_waitcnt vmcnt(11)
  v_mfma_f32_16x16x32_bf16 v[28:31], v[208:211], v[80:83], v[28:31]
  s_waitcnt vmcnt(10)
  v_mfma_f32_16x16x32_bf16 v[28:31], v[212:215], v[84:87], v[28:31]
  s_waitcnt vmcnt(9)
  v_mfma_f32_16x16x32_bf16 v[28:31], v[216:219], v[88:91], v[28:31]
  s_waitcnt vmcnt(8)
  v_mfma_f32_16x16x32_bf16 v[28:31], v[220:223], v[92:95], v[28:31]
  s_waitcnt vmcnt(7)
  v_mfma_f32_16x16x32_bf16 v[28:31], v[224:227], v[96:99], v[28:31]
  s_waitcnt vmcnt(6)
  v_mfma_f32_16x16x32_bf16 v[28:31], v[228:231], v[100:103], v[28:31]
  s_waitcnt vmcnt(5)
  v_mfma_f32_16x16x32_bf16 v[28:31], v[232:235], v[104:107], v[28:31]
  s_waitcnt vmcnt(4)
  v_mfma_f32_16x16x32_bf16 v[28:31], v[236:239], v[108:111], v[28:31]
  s_waitcnt vmcnt(3)
  v_mfma_f32_16x16x32_bf16 v[28:31], v[240:243], v[112:115], v[28:31]
  s_waitcnt vmcnt(2)
  v_mfma_f32_16x16x32_bf16 v[28:31], v[244:247], v[116:119], v[28:31]
  s_waitcnt vmcnt(1)
  v_mfma_f32_16x16x32_bf16 v[28:31], v[248:251], v[120:123], v[28:31]
  s_waitcnt vmcnt(0)
  v_mfma_f32_16x16x32_bf16 v[28:31], v[252:255], v[124:127], v[28:31]
L_owr:
  s_mov_b32 exec_lo, 0x00ff00ff
  s_mov_b32 exec_hi, 0x00ff00ff
  s_nop 5
  ds_write2_b32 v61, v28, v29 offset0:0 offset1:8
  ds_write2_b32 v61, v30, v31 offset0:16 offset1:24
  s_mov_b64 exec, -1
  s_waitcnt lgkmcnt(0)
  s_barrier
  s_cbranch_vccz L_mid2
  s_cmp_lg_u32 s101, 0
  s_cbranch_scc1 L_end
  s_lshl_b32 s46, s92, 7
  s_lshl_b32 s78, s91, 11
  s_add_u32 s46, s46, s78
  v_lshrrev_b32 v70, 4, v1
  v_and_b32 v69, 7, v1
  v_and_or_b32 v70, v1, 4, v70
  v_and_b32 v69, 3, v1
  v_lshl_add_u32 v69, v69, 3, v70
  v_lshlrev_b32 v69, 1, v69
  buffer_load_ushort v68, v69, s[48:51], s92 offen
  s_mov_b32 s88, 200000
  v_lshrrev_b32 v63, 3, v1
  v_lshlrev_b32 v63, 5, v63
  s_lshl_b32 s78, s91, 3
  v_add_u32 v63, s78, v63
  ds_read_b64 v[108:109], v63 offset:41024
  v_lshlrev_b32 v63, 1, v69
  v_mov_b32 v70, 0
  ds_read_b32 v124, v63 offset:41792
  ds_read_b32 v64, v70 offset:41920
  v_lshlrev_b32 v71, 3, v69
  s_lshl_b32 s78, s91, 2
  v_add_u32 v73, s78, v71
  v_mov_b32 v72, 1
  s_mov_b32 s77, 0xff
  s_waitcnt lgkmcnt(0)
  v_bfe_u32 v67, v64, 24, 8
  v_bfe_u32 v66, v64, 16, 8
  v_bfe_u32 v65, v64, 8, 8
  v_bfe_u32 v64, v64, 0, 8
  buffer_load_dwordx4 v[128:131], v3, s[68:71], s46 offen offset:0 sc1
  buffer_load_dwordx4 v[132:135], v3, s[68:71], s46 offen offset:1024 sc1
  s_mov_b64 s[4:5], -1
  s_mov_b64 s[6:7], -1
  v_not_b32 v136, v64
  v_not_b32 v140, v64
  v_not_b32 v144, v64
  v_not_b32 v148, v64
  s_mov_b64 exec, 1
  buffer_load_ushort v75, v69, s[48:51], s92 offen
  buffer_load_ushort v75, v69, s[48:51], s92 offen
  buffer_load_ushort v75, v69, s[48:51], s92 offen
  buffer_load_ushort v75, v69, s[48:51], s92 offen
L_poll:
  s_mov_b64 exec, s[4:5]
  s_waitcnt vmcnt(5)
  v_xor_b32 v128, v128, v64
  v_xor_b32 v129, v129, v65
  v_xor_b32 v130, v130, v66
  v_xor_b32 v131, v131, v67
  v_or3_b32 v120, v128, v129, v130
  v_bitop3_b32 v120, v120, v131, s77 bitop3:0xa8
  v_cmp_ne_u32 s[4:5], 0, v120
  v_pk_mul_f32 v[76:77], v[108:109], v[128:129] op_sel_hi:[0,1]
  v_pk_mul_f32 v[78:79], v[108:109], v[130:131] op_sel_hi:[0,1]
  s_mov_b64 exec, s[6:7]
  s_waitcnt vmcnt(4)
  v_xor_b32 v132, v132, v64
  v_xor_b32 v133, v133, v65
  v_xor_b32 v134, v134, v66
  v_xor_b32 v135, v135, v67
  v_or3_b32 v120, v132, v133, v134
  v_bitop3_b32 v120, v120, v135, s77 bitop3:0xa8
  v_cmp_ne_u32 s[6:7], 0, v120
  v_pk_mul_f32 v[80:81], v[108:109], v[132:133] op_sel:[1,0]
  v_pk_mul_f32 v[82:83], v[108:109], v[134:135] op_sel:[1,0]
  s_or_b64 s[8:9], s[4:5], s[6:7]
  s_cbranch_scc0 L_done
  s_or_b32 s4, s4, 1
  s_mov_b64 exec, s[4:5]
  buffer_load_dwordx4 v[128:131], v3, s[68:71], s46 offen offset:0 sc1
  s_or_b32 s6, s6, 1
  s_mov_b64 exec, s[6:7]
  buffer_load_dwordx4 v[132:135], v3, s[68:71], s46 offen offset:1024 sc1
  s_mov_b64 exec, s[4:5]
  s_waitcnt vmcnt(5)
  v_xor_b32 v136, v136, v64
  v_xor_b32 v137, v137, v65
  v_xor_b32 v138, v138, v66
  v_xor_b32 v139, v139, v67
  v_or3_b32 v120, v136, v137, v138
  v_bitop3_b32 v120, v120, v139, s77 bitop3:0xa8
  v_cmp_ne_u32 s[4:5], 0, v120
  v_pk_mul_f32 v[76:77], v[108:109], v[136:137] op_sel_hi:[0,1]
  v_pk_mul_f32 v[78:79], v[108:109], v[138:139] op_sel_hi:[0,1]
  s_mov_b64 exec, s[6:7]
  s_waitcnt vmcnt(4)
  v_xor_b32 v140, v140, v64
  v_xor_b32 v141, v141, v65
  v_xor_b32 v142, v142, v66
  v_xor_b32 v143, v143, v67
  v_or3_b32 v120, v140, v141, v142
  v_bitop3_b32 v120, v120, v143, s77 bitop3:0xa8
  v_cmp_ne_u32 s[6:7], 0, v120
  v_pk_mul_f32 v[80:81], v[108:109], v[140:141] op_sel:[1,0]
  v_pk_mul_f32 v[82:83], v[108:109], v[142:143] op_sel:[1,0]
  s_or_b64 s[8:9], s[4:5], s[6:7]
  s_cbranch_scc0 L_done
  s_or_b32 s4, s4, 1
  s_mov_b64 exec, s[4:5]
  buffer_load_dwordx4 v[136:139], v3, s[68:71], s46 offen offset:0 sc1
  s_or_b32 s6, s6, 1
  s_mov_b64 exec, s[6:7]
  buffer_load_dwordx4 v[140:143], v3, s[68:71], s46 offen offset:1024 sc1
  s_mov_b64 exec, s[4:5]
  s_waitcnt vmcnt(5)
  v_xor_b32 v144, v144, v64
  v_xor_b32 v145, v145, v65
  v_xor_b32 v146, v146, v66
  v_xor_b32 v147, v147, v67
  v_or3_b32 v120, v144, v145, v146
  v_bitop3_b32 v120, v120, v147, s77 bitop3:0xa8
  v_cmp_ne_u32 s[4:5], 0, v120
  v_pk_mul_f32 v[76:77], v[108:109], v[144:145] op_sel_hi:[0,1]
  v_pk_mul_f32 v[78:79], v[108:109], v[146:147] op_sel_hi:[0,1]
  s_mov_b64 exec, s[6:7]
  s_waitcnt vmcnt(4)
  v_xor_b32 v148, v148, v64
  v_xor_b32 v149, v149, v65
  v_xor_b32 v150, v150, v66
  v_xor_b32 v151, v151, v67
  v_or3_b32 v120, v148, v149, v150
  v_bitop3_b32 v120, v120, v151, s77 bitop3:0xa8
  v_cmp_ne_u32 s[6:7], 0, v120
  v_pk_mul_f32 v[80:81], v[108:109], v[148:149] op_sel:[1,0]
  v_pk_mul_f32 v[82:83], v[108:109], v[150:151] op_sel:[1,0]
  s_or_b64 s[8:9], s[4:5], s[6:7]
  s_cbranch_scc0 L_done
  s_or_b32 s4, s4, 1
  s_mov_b64 exec, s[4:5]
  buffer_load_dwordx4 v[144:147], v3, s[68:71], s46 offen offset:0 sc1
  s_or_b32 s6, s6, 1
  s_mov_b64 exec, s[6:7]
  buffer_load_dwordx4 v[148:151], v3, s[68:71], s46 offen offset:1024 sc1
  s_sub_u32 s88, s88, 1
  s_cbranch_scc0 L_poll
L_done:
  s_mov_b64 exec, -1
  v_pk_add_f32 v[116:117], v[76:77], v[80:81]
  v_pk_add_f32 v[118:119], v[78:79], v[82:83]
  v_lshlrev_b32 v68, 16, v68
  s_nop 0
  v_permlane32_swap_b32 v116, v118
  v_permlane32_swap_b32 v117, v119
  v_add_f32 v116, v116, v118
  v_add_f32 v117, v117, v119
  s_nop 1
  v_permlane16_swap_b32 v116, v117
  v_add_f32 v116, v116, v117
  s_nop 1
  v_add_f32_dpp v116, v116, v116 row_ror:8 row_mask:0xf bank_mask:0xf
  ds_write_b32 v73, v116 offset:41280
  s_mov_b64 exec, 1
  ds_add_rtn_u32 v120, v70, v72 offset:41924
  s_mov_b32 exec_lo, 0x00ff00ff
  s_mov_b32 exec_hi, 0x00ff00ff
  ds_read_b128 v[116:119], v71 offset:41280
  s_waitcnt lgkmcnt(0)
  v_readfirstlane_b32 s78, v120
  v_add_f32 v116, v116, v117
  v_add_f32 v118, v118, v119
  v_add_f32 v116, v116, v118
  s_cmp_lg_u32 s78, 3
  s_cbranch_scc1 L_end3
  v_cvt_pk_bf16_f32 v116, v116, v116
  v_and_b32 v116, s82, v116
  v_mul_f32 v116, v116, v124
  v_cvt_pk_bf16_f32 v116, v116, v116
  v_and_b32 v116, s82, v116
  v_add_f32 v116, v116, v68
  v_cvt_pk_bf16_f32 v116, v116, v116
  buffer_store_short v116, v69, s[64:67], s92 offen
L_end:
L_end3:
  s_endpgm
L_e4:
  s_cmp_lg_u32 s88, 47
  s_cbranch_scc1 L_mid
  s_mov_b32 s45, 48
  s_add_u32 s75, s75, 266338304
  s_branch L_v
L_mid:
  v_add_f32_dpp v33, v33, v33 row_ror:4 row_mask:0xf bank_mask:0xf
  v_add_f32_dpp v35, v35, v35 row_ror:4 row_mask:0xf bank_mask:0xf
  s_nop 0
  v_add_f32_dpp v33, v33, v33 row_ror:8 row_mask:0xf bank_mask:0xf
  v_add_f32_dpp v35, v35, v35 row_ror:8 row_mask:0xf bank_mask:0xf
  v_readlane_b32 s84, v33, 0
  v_readlane_b32 s85, v33, 16
  v_readlane_b32 s86, v33, 32
  v_readlane_b32 s87, v33, 48
  v_readlane_b32 s52, v35, 0
  v_readlane_b32 s53, v35, 16
  v_readlane_b32 s54, v35, 32
  v_readlane_b32 s55, v35, 48
  v_mov_b32 v33, s84
  v_mov_b32 v35, s52
  v_add_f32 v33, s85, v33
  v_add_f32 v35, s53, v35
  v_add_f32 v33, s86, v33
  v_add_f32 v35, s54, v35
  v_add_f32 v33, s87, v33
  v_add_f32 v35, s55, v35
  s_mov_b64 exec, 1
  ds_write_b128 v62, v[32:35] offset:40960
  s_branch L_owr
L_mid2:
  s_mov_b32 s45, 63
  v_mov_b32 v28, 0
  v_mov_b32 v29, 0
  v_mov_b32 v30, 0
  v_mov_b32 v31, 0
  v_mov_b32 v16, v17
  v_add_u32 v61, 2048, v61
  s_branch L_v
.section .rodata,"a"
.p2align 6
.amdhsa_kernel recurrent_scan__mha_block_cached__mixer_token_mlp__decode_kernel
  .amdhsa_next_free_vgpr 256
  .amdhsa_next_free_sgpr 102
  .amdhsa_accum_offset 256
  .amdhsa_group_segment_fixed_size 0
  .amdhsa_kernarg_size 104
  .amdhsa_user_sgpr_count 2
  .amdhsa_user_sgpr_kernarg_segment_ptr 1
  .amdhsa_system_sgpr_workgroup_id_x 1
.end_amdhsa_kernel
```
